```python
import torch

def _softmax(x, axis=-1):
    return torch.softmax(x, dim=axis)
def _gelu(x):
    return torch.nn.functional.gelu(x, approximate="tanh")
def _silu(x):
    return torch.nn.functional.silu(x)
def _sigmoid(x):
    return torch.sigmoid(x)
def _layernorm(x, axis=-1, eps=1e-5):
    m = x.mean(dim=axis, keepdim=True)
    v = x.var(dim=axis, keepdim=True, unbiased=False)
    return (x - m) / torch.sqrt(v + eps)
def _scatter_add(tgt, idx, src, axis=0):
    return tgt.clone().index_add_(axis, idx, src)
def _segment_sum(src, seg, n):
    out = torch.zeros((n,) + src.shape[1:], dtype=src.dtype)
    return out.index_add_(0, seg, src)
def _pad(x, pw):
    flat = tuple(v for pair in reversed(pw) for v in pair)
    return torch.nn.functional.pad(x, flat)

kernel_name = 'gated_mix__compressed_kv_cla__dense_activation_silu__decode'

def setup_inputs():

    _w = (lambda a: (lambda t: t.to(torch.bfloat16) if t.is_floating_point() else t)(torch.as_tensor(a)))
    def _A_setup():
        B, H, Sq, Sk, D, M = 2, 32, 1, 8192, 128, 512
        Dc = 4 * D
        return {
            "x": _w((lambda *s: torch.randn(*s, dtype=torch.bfloat16) * 0.05)(B, Sq, M)),
            "c_kv": _w((lambda *s: torch.randn(*s, dtype=torch.bfloat16) * 0.8)(B, Sk, Dc)),
            "w_q": _w((lambda *s: torch.randn(*s, dtype=torch.bfloat16) * 6.4)(M, H, D) * (M ** -0.5)),
            "w_uk": _w((lambda *s: torch.randn(*s, dtype=torch.bfloat16) * 6.4)(Dc, H, D) * (Dc ** -0.5)),
            "w_uv": _w((lambda *s: torch.randn(*s, dtype=torch.bfloat16) * 0.8)(Dc, H, D) * (Dc ** -0.5)),
            "w_o": _w((lambda *s: torch.randn(*s, dtype=torch.bfloat16) * 0.8)(H, D, M) * ((H * D) ** -0.5)),
        }
    _A_in = _A_setup()

    def _B_setup():
        B, S, D, F = 2, 1, 512, 1792
        return {
            "x": _w((lambda *s: torch.randn(*s, dtype=torch.bfloat16) * 0.05)(B, S, D)),
            "w1": _w((lambda *s: torch.randn(*s, dtype=torch.bfloat16) * 3.2)(D, F) * (D ** -0.5)),
            "w2": _w((lambda *s: torch.randn(*s, dtype=torch.bfloat16) * 1.6)(F, D) * (F ** -0.5)),
        }
    _B_in = _B_setup()

    return {
        "A_x": _A_in["x"],
        "A_c_kv": _A_in["c_kv"],
        "A_w_q": _A_in["w_q"],
        "A_w_uk": _A_in["w_uk"],
        "A_w_uv": _A_in["w_uv"],
        "A_w_o": _A_in["w_o"],
        "B_x": _B_in["x"],
        "B_w1": _B_in["w1"],
        "B_w2": _B_in["w2"],
        "gate_w": _w((lambda *s: torch.randn(*s, dtype=torch.bfloat16) * 0.05)(512) * 16.0),
    }

def reference(A_x, A_c_kv, A_w_q, A_w_uk, A_w_uv, A_w_o, B_x, B_w1, B_w2, gate_w):
    def _A_ref(x, c_kv, w_q, w_uk, w_uv, w_o):
        B, Sq, M = x.shape[0], x.shape[1], x.shape[2]
        Sk = c_kv.shape[1]
        H, D = w_q.shape[1], w_q.shape[2]
        q = torch.einsum("bqm,mhd->bhqd", x, w_q)
        k = torch.einsum("bkc,chd->bhkd", c_kv, w_uk)
        v = torch.einsum("bkc,chd->bhkd", c_kv, w_uv)
        scores = torch.einsum("bhqd,bhkd->bhqk", q, k) * (D ** -0.5)
        off = Sk - Sq
        qi = torch.arange(Sq)[:, None]
        kj = torch.arange(Sk)[None, :]
        cmask = kj <= (qi + off)
        scores = torch.where(cmask[None, None], scores, -1e9)
        p = _softmax(scores, axis=-1)
        ctx = torch.einsum("bhqk,bhkd->bhqd", p, v)
        return torch.einsum("bhqd,hdm->bqm", ctx, w_o)

    def _B_ref(x, w1, w2):
        h = torch.einsum("bsd,df->bsf", x, w1)
        h = _silu(h)
        out = torch.einsum("bsf,fd->bsd", h, w2)
        return out

    x = A_x
    g = _sigmoid((x * gate_w).sum(-1, keepdims=True))
    a = _A_ref(x, A_c_kv, A_w_q, A_w_uk, A_w_uv, A_w_o)
    b = _B_ref(x, B_w1, B_w2)
    return g * a + (1 - g) * b
```

```asm
; @launch grid=(256,1,1) block=(256,1,1) lds=163840
.amdgcn_target "amdgcn-amd-amdhsa--gfx950"
.text
.p2align 12
.globl gated_mix__compressed_kv_cla__dense_activation_silu__decode_kernel
.p2align 8
.type gated_mix__compressed_kv_cla__dense_activation_silu__decode_kernel,@function
gated_mix__compressed_kv_cla__dense_activation_silu__decode_kernel:
s_cmp_ge_u32 s2, 256
s_cbranch_scc1 L_exit
s_load_dwordx16 s[4:19], s[0:1], 0
s_and_b32 s74, s2, 56
s_cbranch_scc1 L_nopf
s_getpc_b64 s[84:85]
L_pc0:
v_lshlrev_b32 v12, 7, v0
v_mov_b32 v13, 0
v_min_u32 v12, L_exit-L_pc0, v12
v_lshl_add_u64 v[12:13], v[12:13], 0, s[84:85]
global_load_dword v253, v[12:13], off
L_nopf:
s_load_dwordx8 s[20:27], s[0:1], 64
s_load_dwordx2 s[28:29], s[0:1], 96
v_lshrrev_b32 v2, 6, v0
v_and_b32 v1, 63, v0
v_readfirstlane_b32 s3, v2
s_and_b32 s30, s2, 7
s_lshr_b32 s31, s2, 3
s_and_b32 s74, s31, 3
s_lshl_b32 s72, s30, 2
s_add_u32 s72, s72, s74
s_bfe_u32 s73, s31, 0x20002
s_lshl_b32 s75, s72, 2
s_add_u32 s75, s75, s73
s_lshl_b32 s76, s73, 2
s_add_u32 s76, s76, s3
s_lshl_b32 s76, s76, 18
s_lshl_b32 s74, s72, 8
s_add_u32 s76, s76, s74
s_lshl_b32 s77, s3, 13
v_lshrrev_b32 v8, 4, v1
v_and_b32 v9, 15, v1
v_lshlrev_b32 v4, 1, v8
v_xor_b32 v4, v4, v9
v_lshlrev_b32_e64 v4, 4, v4
v_lshl_add_u32 v4, v8, 13, v4
v_xor_b32_e64 v5, 16, v4
v_xor_b32 v6, 128, v4
v_xor_b32 v7, 144, v4
s_mov_b32 s38, 4194304
s_mov_b32 s39, 0x00020000
s_cmp_ge_u32 s2, 128
s_cselect_b32 s78, 131072, 0
s_cselect_b32 s79, 131072, 0
s_add_u32 s78, s78, s77
s_add_u32 s79, s79, s76
s_waitcnt lgkmcnt(0)
s_mov_b32 s36, s8
s_mov_b32 s37, s9
s_add_u32 m0, s78, 0
s_add_u32 s74, s79, 0
buffer_load_dwordx4 v4, s[36:39], s74 offen  lds
s_add_u32 m0, s78, 1024
s_add_u32 s74, s79, 32768
buffer_load_dwordx4 v5, s[36:39], s74 offen  lds
s_add_u32 m0, s78, 2048
s_add_u32 s74, s79, 65536
buffer_load_dwordx4 v6, s[36:39], s74 offen  lds
s_add_u32 m0, s78, 3072
s_add_u32 s74, s79, 98304
buffer_load_dwordx4 v7, s[36:39], s74 offen  lds
s_cmp_ge_u32 s2, 128
s_cselect_b32 s36, s10, s8
s_cselect_b32 s37, s11, s9
s_cselect_b32 s79, 0, 131072
s_add_u32 s79, s79, s76
s_add_u32 m0, s78, 4096
s_add_u32 s74, s79, 0
buffer_load_dwordx4 v4, s[36:39], s74 offen  lds
s_add_u32 m0, s78, 5120
s_add_u32 s74, s79, 32768
buffer_load_dwordx4 v5, s[36:39], s74 offen  lds
s_add_u32 m0, s78, 6144
s_add_u32 s74, s79, 65536
buffer_load_dwordx4 v6, s[36:39], s74 offen  lds
s_add_u32 m0, s78, 7168
s_add_u32 s74, s79, 98304
buffer_load_dwordx4 v7, s[36:39], s74 offen  lds
s_cmp_ge_u32 s2, 128
s_cbranch_scc1 L_at
L_ft:
s_mov_b32 s60, s4
s_mov_b32 s61, s5
s_mov_b32 s62, 2048
s_mov_b32 s63, 0x00020000
v_and_b32 v56, 1, v1
v_lshrrev_b32 v57, 4, v1
v_lshlrev_b32_e64 v57, 4, v57
v_lshl_add_u32 v56, v56, 10, v57
s_lshl_b32 s84, s73, 8
buffer_load_dwordx4 v[20:23], v56, s[60:63], s84 offen offset:0
buffer_load_dwordx4 v[24:27], v56, s[60:63], s84 offen offset:64
buffer_load_dwordx4 v[28:31], v56, s[60:63], s84 offen offset:128
buffer_load_dwordx4 v[32:35], v56, s[60:63], s84 offen offset:192
s_mov_b32 s40, s10
s_mov_b32 s41, s11
s_mov_b32 s42, 4194304
s_mov_b32 s43, 0x00020000
s_load_dword s95, s[28:29], 0
s_mov_b32 s32, s28
s_mov_b32 s33, s29
s_mov_b32 s34, 7077888
s_mov_b32 s35, 0x00020000
v_lshlrev_b32 v197, 4, v1
v_lshlrev_b32 v196, 3, v1
s_lshl_b32 s74, s3, 9
s_lshl_b32 s80, s75, 11
s_add_u32 s80, s80, s74
s_add_u32 s84, s73, 1
s_and_b32 s84, s84, 3
s_lshl_b32 s85, s72, 2
s_add_u32 s84, s84, s85
s_lshl_b32 s84, s84, 11
s_add_u32 s81, s84, s74
s_add_u32 s84, s73, 2
s_and_b32 s84, s84, 3
s_lshl_b32 s85, s72, 2
s_add_u32 s84, s84, s85
s_lshl_b32 s84, s84, 11
s_add_u32 s82, s84, s74
s_add_u32 s84, s73, 3
s_and_b32 s84, s84, 3
s_lshl_b32 s85, s72, 2
s_add_u32 s84, s84, s85
s_lshl_b32 s84, s84, 11
s_add_u32 s83, s84, s74
v_lshrrev_b32_e64 v56, 4, v1
v_bfe_u32 v57, v1, 2, 2
v_lshl_add_u32 v36, v56, 3, v57
v_lshlrev_b32 v36, 8, v36
v_and_b32 v56, 1, v56
v_lshlrev_b32_e64 v56, 3, v56
v_lshl_or_b32 v56, v57, 1, v56
v_bfe_u32 v58, v1, 1, 1
v_xor_b32_e64 v56, v56, v58
v_lshl_add_u32 v36, v56, 4, v36
v_and_b32_e64 v58, 1, v1
v_lshl_add_u32 v36, v58, 3, v36
s_lshl_b32 s74, s3, 6
v_xor_b32 v36, s74, v36
v_xor_b32 v37, 32, v36
v_xor_b32 v38, 16, v36
v_add_u32 v38, 1024, v38
v_xor_b32_e64 v39, 16, v37
v_add_u32 v39, 1024, v39
v_and_b32_e64 v56, 3, v1
v_bfe_u32 v57, v1, 3, 2
v_bfe_u32 v58, v1, 2, 1
v_lshl_add_u32 v48, v57, 2, v56
v_lshl_add_u32 v48, v58, 4, v48
v_lshlrev_b32 v48, 8, v48
v_lshlrev_b32 v56, 1, v56
v_lshrrev_b32_e64 v59, 1, v57
v_lshl_or_b32 v56, v59, 3, v56
v_and_b32 v57, 1, v57
v_or_b32 v56, v56, v57
v_lshrrev_b32 v59, 5, v1
v_xor_b32 v56, v56, v59
v_lshl_add_u32 v48, v56, 4, v48
s_add_u32 s74, s77, 32768
v_add_u32 v48, s74, v48
v_xor_b32 v49, 32, v48
v_xor_b32_e64 v50, 64, v48
v_xor_b32 v51, 96, v48
v_xor_b32 v52, 128, v48
v_xor_b32 v53, 160, v48
v_xor_b32 v54, 192, v48
v_xor_b32 v55, 224, v48
s_mov_b32 s90, 0xffff0000
s_mov_b32 s91, 0xffff0000
s_mov_b32 s92, 0
s_mov_b32 s93, -1
v_lshrrev_b32_e64 v56, 5, v1
v_mul_u32_u24 v56, 272, v56
v_and_b32_e64 v57, 31, v1
v_lshl_add_u32 v198, v57, 1, v56
s_lshl_b32 s74, s3, 6
s_add_u32 s74, s74, 131072
v_add_u32 v198, s74, v198
v_and_b32_e64 v56, 1, v1
v_mul_u32_u24 v56, 272, v56
v_add_u32 v56, 131072, v56
v_lshrrev_b32_e64 v57, 4, v1
v_lshl_add_u32 v199, v57, 4, v56
v_lshrrev_b32_e64 v57, 5, v1
v_lshl_add_u32 v200, v57, 4, v56
v_and_b32_e64 v56, 1, v1
v_mul_u32_u24 v56, 384, v56
v_bfe_u32 v58, v1, 1, 4
v_lshl_add_u32 v56, v58, 7, v56
v_lshl_add_u32 v56, v57, 4, v56
s_lshl_b32 s74, s3, 5
s_add_u32 s74, s74, 134144
v_add_u32 v233, s74, v56
v_add_u32 v234, 134144, v197
v_cmp_le_u32 vcc, 24, v1
v_add_u32 v57, 48768, v197
s_nop 0
v_cndmask_b32 v235, v197, v57, vcc
s_waitcnt lgkmcnt(0)
s_add_u32 s30, s95, 2654435769
v_mov_b32 v191, s30
v_not_b32 v193, s30
v_mov_b32_e64 v192, 0
s_add_u32 s74, s80, 458752
buffer_store_dwordx2 v[192:193], v196, s[32:35], s74 offen sc1
s_mov_b32 s44, s12
s_mov_b32 s45, s13
s_mov_b32 s46, 4194304
s_mov_b32 s47, 0x00020000
s_mov_b32 s48, s14
s_mov_b32 s49, s15
s_mov_b32 s50, 4194304
s_mov_b32 s51, 0x00020000
s_mov_b32 s52, s18
s_mov_b32 s53, s19
s_mov_b32 s54, 1835008
s_mov_b32 s55, 0x00020000
s_mov_b32 s56, s20
s_mov_b32 s57, s21
s_mov_b32 s58, 1835008
s_mov_b32 s59, 0x00020000
s_mov_b32 s64, s22
s_mov_b32 s65, s23
s_mov_b32 s66, 1024
s_mov_b32 s67, 0x00020000
s_mov_b32 s68, s24
s_mov_b32 s69, s25
s_mov_b32 s70, 2048
s_mov_b32 s71, 0x00020000
buffer_load_dwordx4 v[204:207], v197, s[60:63], 0 offen
buffer_load_dwordx4 v[208:211], v197, s[60:63], 0 offen offset:1024
buffer_load_dwordx4 v[212:215], v197, s[64:67], 0 offen
s_lshl_b32 s10, s72, 14
s_lshl_b32 s74, s3, 9
s_add_u32 s10, s10, s74
s_lshl_b32 s11, s73, 11
s_add_u32 s11, s11, s10
s_lshl_b32 s12, s75, 2
s_add_u32 s12, s12, s3
s_and_b32 s74, s12, 31
s_lshl_b32 s74, s74, 8
s_lshr_b32 s12, s12, 5
s_lshl_b32 s12, s12, 14
s_add_u32 s12, s12, s74
s_add_u32 s12, s12, 720896
v_not_b32 v185, s30
v_mov_b32 v184, 0
s_add_u32 s74, s11, 1048576
buffer_store_dwordx2 v[184:185], v196, s[32:35], s74 offen sc1
s_add_u32 s74, s11, 1056768
buffer_store_dwordx2 v[184:185], v196, s[32:35], s74 offen sc1
s_add_u32 s74, s11, 1572864
buffer_store_dwordx2 v[184:185], v196, s[32:35], s74 offen sc1
s_add_u32 s74, s11, 1581056
buffer_store_dwordx2 v[184:185], v196, s[32:35], s74 offen sc1
v_lshrrev_b32 v56, 4, v1
v_and_b32 v57, 15, v1
v_lshlrev_b32 v8, 1, v56
v_xor_b32 v8, v8, v57
v_lshlrev_b32_e64 v8, 4, v8
v_lshl_add_u32 v8, v56, 10, v8
v_xor_b32_e64 v9, 16, v8
v_xor_b32 v10, 128, v8
v_xor_b32 v11, 144, v8
v_lshrrev_b32 v56, 4, v1
v_and_b32 v57, 15, v1
v_lshlrev_b32 v12, 1, v56
v_xor_b32 v12, v12, v57
v_lshlrev_b32_e64 v12, 4, v12
v_lshl_add_u32 v12, v56, 17, v12
v_xor_b32_e64 v13, 16, v12
v_xor_b32 v14, 128, v12
v_xor_b32 v15, 144, v12
v_lshrrev_b32_e64 v56, 3, v1
v_mul_u32_u24 v56, 3584, v56
v_bfe_u32 v57, v1, 4, 1
v_lshlrev_b32 v57, 1, v57
v_and_b32 v58, 7, v1
v_xor_b32 v57, v57, v58
v_xor_b32 v58, 4, v57
v_min_u32 v57, 6, v57
v_min_u32 v58, 6, v58
v_lshl_add_u32 v16, v57, 4, v56
v_lshl_add_u32 v17, v58, 4, v56
s_lshl_b32 s4, s73, 2
s_add_u32 s4, s4, s3
s_mul_i32 s4, s4, 114688
s_mul_i32 s74, s72, 112
s_add_u32 s4, s4, s74
s_lshl_b32 s100, s3, 12
s_mul_i32 s99, s72, 56
s_lshl_b32 s74, s3, 4
s_add_u32 s99, s99, s74
s_lshl_b32 s99, s99, 10
s_lshl_b32 s8, s73, 8
s_add_u32 s99, s99, s8
s_lshl_b32 s5, s73, 5
s_mov_b32 s74, s3
s_add_u32 s5, s5, s74
s_lshl_b32 s5, s5, 15
s_lshl_b32 s74, s72, 8
s_add_u32 s5, s5, s74
s_lshl_b32 s98, s72, 2
s_add_u32 s98, s98, s3
s_lshl_b32 s98, s98, 15
s_add_u32 s98, s98, s8
s_lshl_b32 s100, s3, 12
s_mov_b32 s16, s6
s_mov_b32 s17, s7
s_mov_b32 s18, 16777216
s_mov_b32 s19, 0x00020000
s_and_b32 s79, s2, 7
s_lshl_b32 s79, s79, 4
s_add_u32 s79, s79, s31
s_mul_i32 s74, s3, 20
s_xor_b32 s79, s79, s74
s_lshl_b32 s79, s79, 2
s_add_u32 s79, s79, s3
s_lshl_b32 s79, s79, 15
s_waitcnt vmcnt(8)
s_barrier
ds_read_b64_tr_b16 v[64:65], v36 offset:0
ds_read_b64_tr_b16 v[66:67], v38 offset:0
ds_read_b64_tr_b16 v[68:69], v37 offset:0
ds_read_b64_tr_b16 v[70:71], v39 offset:0
ds_read_b64_tr_b16 v[72:73], v36 offset:8192
ds_read_b64_tr_b16 v[74:75], v38 offset:8192
ds_read_b64_tr_b16 v[76:77], v37 offset:8192
ds_read_b64_tr_b16 v[78:79], v39 offset:8192
ds_read_b64_tr_b16 v[80:81], v36 offset:16384
ds_read_b64_tr_b16 v[82:83], v38 offset:16384
ds_read_b64_tr_b16 v[84:85], v37 offset:16384
ds_read_b64_tr_b16 v[86:87], v39 offset:16384
ds_read_b64_tr_b16 v[88:89], v36 offset:24576
ds_read_b64_tr_b16 v[90:91], v38 offset:24576
ds_read_b64_tr_b16 v[92:93], v37 offset:24576
s_waitcnt lgkmcnt(14)
ds_read_b64_tr_b16 v[94:95], v39 offset:24576
s_add_u32 s74, s80, 458752
s_add_u32 s85, s81, 458752
s_add_u32 s86, s82, 458752
s_add_u32 s87, s83, 458752
s_waitcnt lgkmcnt(14)
v_mfma_f32_16x16x32_bf16 v[160:163], v[20:23], v[64:67], 0
s_waitcnt lgkmcnt(12)
v_mfma_f32_16x16x32_bf16 v[164:167], v[20:23], v[68:71], 0
s_waitcnt lgkmcnt(10)
v_mfma_f32_16x16x32_bf16 v[160:163], v[24:27], v[72:75], v[160:163]
s_waitcnt lgkmcnt(8)
v_mfma_f32_16x16x32_bf16 v[164:167], v[24:27], v[76:79], v[164:167]
s_waitcnt lgkmcnt(6)
v_mfma_f32_16x16x32_bf16 v[160:163], v[28:31], v[80:83], v[160:163]
s_waitcnt lgkmcnt(4)
v_mfma_f32_16x16x32_bf16 v[164:167], v[28:31], v[84:87], v[164:167]
s_waitcnt lgkmcnt(2)
v_mfma_f32_16x16x32_bf16 v[160:163], v[32:35], v[88:91], v[160:163]
s_waitcnt lgkmcnt(0)
v_mfma_f32_16x16x32_bf16 v[164:167], v[32:35], v[92:95], v[164:167]
s_nop 7
v_cndmask_b32 v56, v160, v164, s[90:91]
v_cndmask_b32 v57, v161, v165, s[90:91]
v_cndmask_b32 v190, v56, v57, s[92:93]
buffer_store_dwordx2 v[190:191], v196, s[32:35], s74 offen sc1
s_add_u32 m0, s77, 32768
s_add_u32 s74, s76, 0
buffer_load_dwordx4 v4, s[40:43], s74 offen  lds
s_add_u32 m0, s77, 33792
s_add_u32 s74, s76, 32768
buffer_load_dwordx4 v5, s[40:43], s74 offen  lds
s_add_u32 m0, s77, 34816
s_add_u32 s74, s76, 65536
buffer_load_dwordx4 v6, s[40:43], s74 offen  lds
s_add_u32 m0, s77, 35840
s_add_u32 s74, s76, 98304
buffer_load_dwordx4 v7, s[40:43], s74 offen  lds
s_add_u32 m0, s77, 36864
s_add_u32 s74, s76, 131072
buffer_load_dwordx4 v4, s[40:43], s74 offen  lds
s_add_u32 m0, s77, 37888
s_add_u32 s74, s76, 163840
buffer_load_dwordx4 v5, s[40:43], s74 offen  lds
s_add_u32 m0, s77, 38912
s_add_u32 s74, s76, 196608
buffer_load_dwordx4 v6, s[40:43], s74 offen  lds
s_add_u32 m0, s77, 39936
s_add_u32 s74, s76, 229376
buffer_load_dwordx4 v7, s[40:43], s74 offen  lds
s_waitcnt vmcnt(0)
buffer_load_dwordx2 v[184:185], v196, s[32:35], s85 offen sc1
buffer_load_dwordx2 v[186:187], v196, s[32:35], s86 offen sc1
buffer_load_dwordx2 v[188:189], v196, s[32:35], s87 offen sc1
ds_read_b128 v[96:99], v48
ds_read_b128 v[100:103], v49
ds_read_b128 v[104:107], v50
ds_read_b128 v[108:111], v51
ds_read_b128 v[112:115], v52
ds_read_b128 v[116:119], v53
ds_read_b128 v[120:123], v54
ds_read_b128 v[124:127], v55
s_mov_b32 s94, 0
s_waitcnt vmcnt(0)
v_xor_b32 v56, s30, v185
v_xor_b32 v57, s30, v187
v_xor_b32 v58, s30, v189
v_or3_b32 v56, v56, v57, v58
v_cmp_ne_u32 vcc, 0, v56
s_cbranch_vccz L_h1_ok_2
L_h1_1:
buffer_load_dwordx2 v[184:185], v196, s[32:35], s85 offen sc1
buffer_load_dwordx2 v[186:187], v196, s[32:35], s86 offen sc1
buffer_load_dwordx2 v[188:189], v196, s[32:35], s87 offen sc1
s_waitcnt vmcnt(0)
v_xor_b32 v56, s30, v185
v_xor_b32 v57, s30, v187
v_xor_b32 v58, s30, v189
v_or3_b32 v56, v56, v57, v58
v_cmp_ne_u32 vcc, 0, v56
s_cbranch_vccz L_h1_ok_2
s_add_u32 s94, s94, 1
s_cmp_lt_u32 s94, 40000
s_cbranch_scc1 L_h1_1
L_h1_ok_2:
v_add_f32 v56, v190, v184
v_add_f32 v57, v186, v188
v_add_f32_e64 v56, v56, v57
v_mul_f32 v56, 0x3e0293ee, v56
v_cvt_pk_bf16_f32 v56, v56, v56
ds_write_b16 v198, v56 offset:0
s_waitcnt lgkmcnt(0)
s_barrier
ds_read_b128 v[128:131], v200 offset:0
ds_read_b128 v[132:135], v200 offset:32
ds_read_b128 v[136:139], v200 offset:64
ds_read_b128 v[140:143], v200 offset:96
ds_read_b128 v[144:147], v200 offset:128
ds_read_b128 v[148:151], v200 offset:160
ds_read_b128 v[152:155], v200 offset:192
ds_read_b128 v[156:159], v200 offset:224
s_waitcnt lgkmcnt(7)
v_mfma_f32_32x32x16_bf16 v[160:175], v[96:99], v[128:131], 0
s_waitcnt lgkmcnt(6)
v_mfma_f32_32x32x16_bf16 v[160:175], v[100:103], v[132:135], v[160:175]
s_waitcnt lgkmcnt(5)
v_mfma_f32_32x32x16_bf16 v[160:175], v[104:107], v[136:139], v[160:175]
s_waitcnt lgkmcnt(4)
v_mfma_f32_32x32x16_bf16 v[160:175], v[108:111], v[140:143], v[160:175]
s_waitcnt lgkmcnt(3)
v_mfma_f32_32x32x16_bf16 v[160:175], v[112:115], v[144:147], v[160:175]
s_waitcnt lgkmcnt(2)
v_mfma_f32_32x32x16_bf16 v[160:175], v[116:119], v[148:151], v[160:175]
s_waitcnt lgkmcnt(1)
v_mfma_f32_32x32x16_bf16 v[160:175], v[120:123], v[152:155], v[160:175]
s_waitcnt lgkmcnt(0)
v_mfma_f32_32x32x16_bf16 v[160:175], v[124:127], v[156:159], v[160:175]
s_mov_b32 s84, 0x0c
s_mov_b32 s85, 0x0c
s_mov_b32 s86, 0x30
s_mov_b32 s87, 0x30
s_mov_b32 s88, 0x3f
s_mov_b32 s89, 0x3f
s_mul_i32 s74, s75, 384
s_add_u32 s74, s74, 65536
s_lshl_b32 s76, s3, 5
s_add_u32 s76, s76, s74
v_mov_b32 v195, s30
s_nop 0
v_cvt_pk_bf16_f32 v56, v160, v161
v_cvt_pk_bf16_f32 v57, v162, v163
v_cvt_pk_bf16_f32 v58, v164, v165
v_cvt_pk_bf16_f32 v59, v166, v167
v_cvt_pk_bf16_f32 v60, v168, v169
v_cvt_pk_bf16_f32 v61, v170, v171
v_cvt_pk_bf16_f32 v62, v172, v173
v_cvt_pk_bf16_f32 v63, v174, v175
v_cndmask_b32 v192, v56, v60, s[84:85]
v_cndmask_b32 v193, v57, v61, s[84:85]
v_cndmask_b32 v194, v58, v62, s[84:85]
v_cndmask_b32 v192, v192, v59, s[86:87]
v_cndmask_b32 v193, v193, v63, s[86:87]
s_mov_b64 exec, s[88:89]
ds_write_b128 v233, v[192:195]
s_mov_b64 exec, -1
s_waitcnt lgkmcnt(0)
s_barrier
s_cmp_lg_u32 s3, 0
s_cbranch_scc1 L_h2done
ds_read_b128 v[192:195], v234
s_mov_b32 exec_hi, 0xffff
s_waitcnt lgkmcnt(0)
buffer_store_dwordx4 v[192:195], v235, s[32:35], s74 offen sc1
s_mov_b64 exec, -1
L_h2done:
s_barrier
s_and_b32 s74, s31, 13
s_cbranch_scc0 L_help_4
s_add_u32 m0, s77, 98304
s_add_u32 s74, s79, 24576
buffer_load_dwordx4 v8, s[16:19], s74 offen  lds
s_add_u32 m0, s77, 99328
s_add_u32 s74, s79, 24832
buffer_load_dwordx4 v8, s[16:19], s74 offen  lds
s_add_u32 m0, s77, 100352
s_add_u32 s74, s79, 25088
buffer_load_dwordx4 v8, s[16:19], s74 offen  lds
s_add_u32 m0, s77, 101376
s_add_u32 s74, s79, 25344
buffer_load_dwordx4 v8, s[16:19], s74 offen  lds
s_add_u32 m0, s77, 102400
s_add_u32 s74, s79, 28672
buffer_load_dwordx4 v8, s[16:19], s74 offen  lds
s_add_u32 m0, s77, 103424
s_add_u32 s74, s79, 28928
buffer_load_dwordx4 v8, s[16:19], s74 offen  lds
s_add_u32 m0, s77, 104448
s_add_u32 s74, s79, 29184
buffer_load_dwordx4 v8, s[16:19], s74 offen  lds
s_add_u32 m0, s77, 105472
s_add_u32 s74, s79, 29440
buffer_load_dwordx4 v8, s[16:19], s74 offen  lds
L_nocpf_3:
s_add_u32 m0, s100, 0
s_add_u32 s74, s4, 0
buffer_load_dwordx4 v16, s[52:55], s74 offen  lds
s_add_u32 m0, s100, 1024
s_add_u32 s74, s4, 28672
buffer_load_dwordx4 v17, s[52:55], s74 offen  lds
s_add_u32 m0, s100, 2048
s_add_u32 s74, s4, 57344
buffer_load_dwordx4 v16, s[52:55], s74 offen  lds
s_add_u32 m0, s100, 3072
s_add_u32 s74, s4, 86016
buffer_load_dwordx4 v17, s[52:55], s74 offen  lds
s_cmp_eq_u32 s73, 1
s_cbranch_scc1 L_ordb_5
s_add_u32 m0, s77, 65536
s_add_u32 s74, s5, 0
buffer_load_dwordx4 v12, s[44:47], s74 offen  lds
s_add_u32 m0, s77, 66560
s_add_u32 s74, s5, 524288
buffer_load_dwordx4 v13, s[44:47], s74 offen  lds
s_add_u32 m0, s77, 67584
s_add_u32 s74, s5, 8192
buffer_load_dwordx4 v14, s[44:47], s74 offen  lds
s_add_u32 m0, s77, 68608
s_add_u32 s74, s5, 532480
buffer_load_dwordx4 v15, s[44:47], s74 offen  lds
s_add_u32 m0, s77, 69632
s_add_u32 s74, s5, 16384
buffer_load_dwordx4 v12, s[44:47], s74 offen  lds
s_add_u32 m0, s77, 70656
s_add_u32 s74, s5, 540672
buffer_load_dwordx4 v13, s[44:47], s74 offen  lds
s_add_u32 m0, s77, 71680
s_add_u32 s74, s5, 24576
buffer_load_dwordx4 v14, s[44:47], s74 offen  lds
s_add_u32 m0, s77, 72704
s_add_u32 s74, s5, 548864
buffer_load_dwordx4 v15, s[44:47], s74 offen  lds
s_add_u32 m0, s77, 98304
s_add_u32 s74, s98, 0
buffer_load_dwordx4 v8, s[48:51], s74 offen  lds
s_add_u32 m0, s77, 99328
s_add_u32 s74, s98, 4096
buffer_load_dwordx4 v9, s[48:51], s74 offen  lds
s_add_u32 m0, s77, 100352
s_add_u32 s74, s98, 8192
buffer_load_dwordx4 v10, s[48:51], s74 offen  lds
s_add_u32 m0, s77, 101376
s_add_u32 s74, s98, 12288
buffer_load_dwordx4 v11, s[48:51], s74 offen  lds
s_add_u32 m0, s77, 102400
s_add_u32 s74, s98, 16384
buffer_load_dwordx4 v8, s[48:51], s74 offen  lds
s_add_u32 m0, s77, 103424
s_add_u32 s74, s98, 20480
buffer_load_dwordx4 v9, s[48:51], s74 offen  lds
s_add_u32 m0, s77, 104448
s_add_u32 s74, s98, 24576
buffer_load_dwordx4 v10, s[48:51], s74 offen  lds
s_add_u32 m0, s77, 105472
s_add_u32 s74, s98, 28672
buffer_load_dwordx4 v11, s[48:51], s74 offen  lds
s_add_u32 m0, s100, 16384
s_add_u32 s74, s99, 0
buffer_load_dwordx4 v8, s[56:59], s74 offen  lds
s_add_u32 m0, s100, 17408
s_add_u32 s74, s99, 4096
buffer_load_dwordx4 v9, s[56:59], s74 offen  lds
s_add_u32 m0, s100, 18432
s_add_u32 s74, s99, 8192
buffer_load_dwordx4 v10, s[56:59], s74 offen  lds
s_add_u32 m0, s100, 19456
s_add_u32 s74, s99, 12288
buffer_load_dwordx4 v11, s[56:59], s74 offen  lds
L_orde_6:
v_add_u32 v40, 0x10000, v36
v_add_u32 v41, 0x10000, v37
v_add_u32 v42, 0x10000, v38
v_add_u32 v43, 0x10000, v39
v_lshrrev_b32_e64 v56, 4, v1
v_bfe_u32 v57, v1, 2, 2
v_lshl_add_u32 v44, v56, 3, v57
v_lshlrev_b32 v44, 7, v44
v_and_b32 v56, 1, v56
v_lshlrev_b32 v56, 2, v56
v_and_b32 v57, 2, v57
v_or_b32_e64 v56, v56, v57
v_bfe_u32 v57, v1, 1, 1
s_lshl_b32 s74, s3, 1
v_or_b32 v57, s74, v57
v_xor_b32_e64 v56, v56, v57
v_lshl_add_u32 v44, v56, 4, v44
v_and_b32_e64 v56, 1, v1
v_lshl_add_u32 v44, v56, 3, v44
v_add_u32_e64 v44, 0, v44
v_add_u32 v45, 512, v44
v_lshrrev_b32_e64 v56, 4, v1
s_and_b32 s74, s3, 1
s_lshl_b32 s74, s74, 3
s_lshr_b32 s76, s3, 1
s_add_u32 s74, s74, s76
v_lshl_add_u32 v56, v56, 1, s74
v_and_b32 v57, 15, v1
v_xor_b32 v58, v57, v56
v_lshlrev_b32_e64 v58, 4, v58
v_lshl_add_u32 v228, v56, 8, v58
v_add_u32 v228, 135168, v228
v_lshrrev_b32 v56, 4, v1
v_xor_b32 v58, v56, v57
v_lshlrev_b32_e64 v58, 4, v58
v_lshl_add_u32 v229, v57, 8, v58
v_add_u32 v229, 135168, v229
s_lshl_b32 s78, s75, 15
s_add_u32 s78, s78, 2097152
s_lshl_b32 s74, s3, 5
s_xor_b32 s76, s74, s75
v_xor_b32 v56, s76, v56
v_lshlrev_b32_e64 v57, 4, v57
v_lshl_add_u32 v48, v56, 8, v57
v_xor_b32_e64 v230, 64, v229
v_xor_b32 v231, 128, v229
v_xor_b32 v232, 192, v229
v_lshrrev_b32 v56, 4, v1
s_and_b32 s74, s75, 31
v_xor_b32_e64 v56, s74, v56
v_lshl_add_u32 v48, v56, 8, v57
s_and_b32 s78, s75, 63
s_lshl_b32 s78, s78, 16
s_lshr_b32 s74, s75, 5
s_xor_b32 s76, s74, s3
s_lshl_b32 s76, s76, 14
s_add_u32 s78, s78, s76
s_and_b32 s74, s74, 1
s_xor_b32 s74, s74, 1
s_lshl_b32 s74, s74, 13
s_add_u32 s78, s78, s74
s_add_u32 s78, s78, 2097152
v_xor_b32 v49, 1024, v48
v_xor_b32 v50, 2048, v48
v_xor_b32 v51, 3072, v48
v_xor_b32 v52, 4096, v48
v_xor_b32 v53, 5120, v48
v_xor_b32 v54, 6144, v48
v_xor_b32 v55, 7168, v48
v_and_b32 v56, 3, v1
v_lshlrev_b32 v56, 2, v56
v_lshrrev_b32 v56, v56, s30
v_bfe_u32 v57, v56, 1, 1
v_bfe_u32 v4, v56, 0, 1
v_lshl_or_b32 v4, v57, 16, v4
v_bfe_u32 v57, v56, 3, 1
v_bfe_u32 v5, v56, 2, 1
v_lshl_or_b32 v5, v57, 16, v5
s_branch L_pg_7
L_at:
s_add_u32 m0, s78, 0
s_add_u32 s74, s76, 131072
buffer_load_dwordx4 v4, s[36:39], s74 offen  lds
s_add_u32 m0, s78, 1024
s_add_u32 s74, s76, 163840
buffer_load_dwordx4 v5, s[36:39], s74 offen  lds
s_add_u32 m0, s78, 2048
s_add_u32 s74, s76, 196608
buffer_load_dwordx4 v6, s[36:39], s74 offen  lds
s_add_u32 m0, s78, 3072
s_add_u32 s74, s76, 229376
buffer_load_dwordx4 v7, s[36:39], s74 offen  lds
s_lshl_b32 s75, s30, 4
s_add_u32 s75, s75, s31
s_sub_u32 s75, s75, 16
s_lshr_b32 s72, s30, 2
s_lshl_b32 s77, s3, 15
s_mul_i32 s74, s3, 20
s_xor_b32 s76, s75, s74
s_lshl_b32 s76, s76, 2
s_add_u32 s76, s76, s3
s_lshl_b32 s76, s76, 15
s_mov_b32 s40, s6
s_mov_b32 s41, s7
s_mov_b32 s42, 16777216
s_mov_b32 s43, 0x00020000
v_lshrrev_b32 v8, 4, v1
v_and_b32 v9, 15, v1
v_lshlrev_b32 v4, 1, v8
v_xor_b32 v4, v4, v9
v_lshlrev_b32_e64 v4, 4, v4
v_lshl_add_u32 v4, v8, 10, v4
v_xor_b32_e64 v5, 16, v4
v_xor_b32 v6, 128, v4
v_xor_b32 v7, 144, v4
s_load_dword s95, s[28:29], 0
s_mov_b32 s32, s28
s_mov_b32 s33, s29
s_mov_b32 s34, 7077888
s_mov_b32 s35, 0x00020000
v_lshrrev_b32 v8, 3, v1
s_lshl_b32 s74, s3, 3
v_add_u32 v8, s74, v8
v_and_b32 v9, 7, v1
v_mul_u32_u24 v16, 1536, v8
v_lshl_add_u32 v16, v9, 4, v16
v_xor_b32 v8, v8, v9
v_lshlrev_b32 v8, 4, v8
v_lshl_add_u32 v17, v9, 10, v8
v_add_u32 v17, 131072, v17
s_mul_i32 s78, s72, 49152
s_add_u32 s78, s78, 65536
v_and_b32 v8, 31, v1
v_lshrrev_b32 v9, 5, v1
v_lshlrev_b32_e64 v9, 9, v9
v_add_u32 v9, 131072, v9
v_xor_b32_e64 v10, 0, v8
v_lshl_add_u32 v20, v10, 4, v9
v_xor_b32_e64 v10, 1, v8
v_lshl_add_u32 v21, v10, 4, v9
v_add_u32 v21, 1024, v21
v_xor_b32_e64 v10, 2, v8
v_lshl_add_u32 v22, v10, 4, v9
v_add_u32 v22, 2048, v22
v_xor_b32_e64 v10, 3, v8
v_lshl_add_u32 v23, v10, 4, v9
v_add_u32 v23, 3072, v23
v_xor_b32_e64 v10, 4, v8
v_lshl_add_u32 v24, v10, 4, v9
v_add_u32 v24, 4096, v24
v_xor_b32_e64 v10, 5, v8
v_lshl_add_u32 v25, v10, 4, v9
v_add_u32 v25, 5120, v25
v_xor_b32_e64 v10, 6, v8
v_lshl_add_u32 v26, v10, 4, v9
v_add_u32 v26, 6144, v26
v_xor_b32_e64 v10, 7, v8
v_lshl_add_u32 v27, v10, 4, v9
v_add_u32 v27, 7168, v27
v_and_b32_e64 v8, 3, v1
v_bfe_u32 v9, v1, 3, 2
v_bfe_u32 v10, v1, 2, 1
v_lshl_add_u32 v28, v9, 2, v8
v_lshl_add_u32 v28, v10, 4, v28
v_lshlrev_b32 v28, 8, v28
v_lshlrev_b32 v8, 1, v8
v_lshrrev_b32_e64 v11, 1, v9
v_lshl_or_b32 v8, v11, 3, v8
v_and_b32 v9, 1, v9
v_or_b32 v8, v8, v9
v_lshrrev_b32 v11, 5, v1
v_xor_b32 v8, v8, v11
v_lshl_add_u32 v28, v8, 4, v28
v_add_u32 v28, s77, v28
v_xor_b32 v29, 32, v28
v_xor_b32_e64 v30, 64, v28
v_xor_b32 v31, 96, v28
v_xor_b32 v32, 128, v28
v_xor_b32 v33, 160, v28
v_xor_b32 v34, 192, v28
v_xor_b32 v35, 224, v28
v_lshrrev_b32_e64 v8, 4, v1
v_bfe_u32 v9, v1, 2, 2
v_lshl_add_u32 v36, v8, 3, v9
v_lshlrev_b32 v36, 8, v36
v_and_b32 v8, 1, v8
v_lshlrev_b32_e64 v8, 3, v8
v_lshl_or_b32 v8, v9, 1, v8
v_bfe_u32 v10, v1, 1, 1
v_xor_b32_e64 v8, v8, v10
v_lshl_add_u32 v36, v8, 4, v36
v_and_b32_e64 v10, 1, v1
v_lshl_add_u32 v36, v10, 3, v36
s_lshl_b32 s74, s3, 13
v_add_u32 v36, s74, v36
v_xor_b32_e64 v44, 16, v36
v_add_u32 v44, 1024, v44
v_xor_b32 v37, 32, v36
v_xor_b32 v38, 64, v36
v_xor_b32 v39, 96, v36
v_xor_b32 v40, 128, v36
v_xor_b32 v41, 160, v36
v_xor_b32 v42, 192, v36
v_xor_b32 v43, 224, v36
v_xor_b32 v45, 32, v44
v_xor_b32 v46, 64, v44
v_xor_b32 v47, 96, v44
v_xor_b32 v48, 128, v44
v_xor_b32 v49, 160, v44
v_xor_b32 v50, 192, v44
v_xor_b32 v51, 224, v44
v_add_u32 v52, 0x10000, v36
v_add_u32 v53, 0x10000, v37
v_add_u32 v54, 0x10000, v38
v_add_u32 v55, 0x10000, v39
v_add_u32 v56, 0x10000, v40
v_add_u32 v57, 0x10000, v41
v_add_u32 v58, 0x10000, v42
v_add_u32 v59, 0x10000, v43
v_add_u32 v60, 0x10000, v44
v_add_u32 v61, 0x10000, v45
v_add_u32 v62, 0x10000, v46
v_add_u32 v63, 0x10000, v47
v_add_u32 v64, 0x10000, v48
v_add_u32 v65, 0x10000, v49
v_add_u32 v66, 0x10000, v50
v_add_u32 v67, 0x10000, v51
v_and_b32 v8, 31, v1
v_lshrrev_b32_e64 v9, 5, v1
s_lshl_b32 s74, s3, 2
v_lshl_add_u32 v9, v9, 1, s74
v_and_b32 v10, 15, v1
v_xor_b32 v9, v9, v10
v_lshlrev_b32_e64 v9, 4, v9
v_lshl_add_u32 v228, v8, 8, v9
v_add_u32 v228, 131072, v228
v_lshrrev_b32 v9, 4, v1
v_xor_b32 v11, v9, v10
v_lshlrev_b32_e64 v11, 4, v11
v_lshl_add_u32 v229, v10, 8, v11
v_add_u32 v229, 131072, v229
v_lshlrev_b32_e64 v233, 2, v8
v_add_u32 v233, 139264, v233
s_lshl_b32 s74, s3, 7
v_add_u32 v236, s74, v233
v_lshlrev_b32 v235, 4, v1
s_xor_b32 s82, s75, s3
v_lshlrev_b32 v11, 4, v9
v_xor_b32 v11, s82, v11
v_lshlrev_b32_e64 v11, 8, v11
v_lshl_add_u32 v234, v9, 19, v11
v_lshl_add_u32 v234, v10, 4, v234
s_lshl_b32 s79, s3, 15
s_add_u32 s79, s79, 2097152
s_lshl_b32 s80, s75, 9
s_add_u32 s80, s80, 196608
s_and_b32 s81, s2, 127
s_lshl_b32 s81, s81, 7
s_add_u32 s81, s81, 1146880
s_mov_b32 s83, 0x00010001
v_xor_b32 v230, 64, v229
v_xor_b32 v231, 128, v229
v_xor_b32 v232, 192, v229
v_lshrrev_b32_e64 v8, 4, v1
v_lshl_add_u32 v9, v8, 4, s3
v_lshlrev_b32 v234, 16, v9
v_lshrrev_b32 v10, 1, v8
s_lshr_b32 s74, s75, 5
v_xor_b32 v11, s74, v10
v_lshl_add_u32 v234, v11, 14, v234
v_xor_b32_e64 v10, 1, v10
v_lshl_add_u32 v234, v10, 13, v234
v_xor_b32 v9, s75, v9
v_and_b32 v9, 31, v9
v_lshl_add_u32 v234, v9, 8, v234
v_and_b32_e64 v9, 15, v1
v_lshl_add_u32 v234, v9, 4, v234
v_and_b32 v8, 31, v1
v_lshlrev_b32 v8, 4, v8
v_lshrrev_b32_e64 v9, 5, v1
v_lshl_add_u32 v235, v9, 13, v8
s_and_b32 s80, s75, 15
s_lshl_b32 s80, s80, 9
s_lshr_b32 s74, s75, 4
s_lshl_b32 s74, s74, 14
s_add_u32 s80, s80, s74
s_add_u32 s80, s80, 196608
s_waitcnt lgkmcnt(0)
s_add_u32 s30, s95, 2654435769
v_mov_b32 v14, s30
v_mov_b32 v15, 0
v_and_b32 v8, 3, v1
v_lshlrev_b32 v8, 2, v8
v_lshrrev_b32 v8, v8, s30
v_bfe_u32 v9, v8, 1, 1
v_bfe_u32 v240, v8, 0, 1
v_lshl_or_b32 v240, v9, 16, v240
v_bfe_u32 v9, v8, 3, 1
v_bfe_u32 v241, v8, 2, 1
v_lshl_or_b32 v241, v9, 16, v241
s_and_b32 s50, s31, 1
s_lshl_b32 s50, s50, 2
s_add_u32 s50, s50, s3
s_cmp_lg_u32 s50, 3
s_cbranch_scc1 L_nomeas_20
s_and_b32 s50, s2, 63
s_lshl_b32 s50, s50, 7
s_bfe_u32 s51, s2, 0x10006
s_lshl_b32 s51, s51, 14
s_add_u32 s50, s50, s51
s_add_u32 s50, s50, 720896
s_bfe_u32 s51, s31, 65537
s_lshl_b32 s52, s51, 13
s_xor_b32 s50, s50, s52
s_xor_b32 s52, s50, 0x2000
s_memtime s[54:55]
s_waitcnt lgkmcnt(0)
s_load_dword s53, s[28:29], s50
s_waitcnt lgkmcnt(0)
s_memtime s[56:57]
s_waitcnt lgkmcnt(0)
s_sub_u32 s53, s56, s54
s_min_u32 s53, s53, 2000
s_xor_b32 s51, s51, s72
s_sub_u32 s52, 0, s53
s_cmp_eq_u32 s51, 0
s_cselect_b32 s53, s53, s52
s_add_u32 s53, s53, 16779264
s_atomic_add s53, s[26:27], 192
L_nomeas_20:
s_add_u32 m0, s77, 0
s_add_u32 s74, s76, 0
buffer_load_dwordx4 v4, s[40:43], s74 offen  lds
s_add_u32 m0, s77, 8192
s_add_u32 s74, s76, 256
buffer_load_dwordx4 v4, s[40:43], s74 offen  lds
s_add_u32 m0, s77, 16384
s_add_u32 s74, s76, 512
buffer_load_dwordx4 v4, s[40:43], s74 offen  lds
s_add_u32 m0, s77, 24576
s_add_u32 s74, s76, 768
buffer_load_dwordx4 v4, s[40:43], s74 offen  lds
s_add_u32 m0, s77, 1024
s_add_u32 s74, s76, 4096
buffer_load_dwordx4 v5, s[40:43], s74 offen  lds
s_add_u32 m0, s77, 9216
s_add_u32 s74, s76, 4352
buffer_load_dwordx4 v5, s[40:43], s74 offen  lds
s_add_u32 m0, s77, 17408
s_add_u32 s74, s76, 4608
buffer_load_dwordx4 v5, s[40:43], s74 offen  lds
s_add_u32 m0, s77, 25600
s_add_u32 s74, s76, 4864
buffer_load_dwordx4 v5, s[40:43], s74 offen  lds
s_add_u32 m0, s77, 2048
s_add_u32 s74, s76, 8192
buffer_load_dwordx4 v6, s[40:43], s74 offen  lds
s_add_u32 m0, s77, 10240
s_add_u32 s74, s76, 8448
buffer_load_dwordx4 v6, s[40:43], s74 offen  lds
s_add_u32 m0, s77, 18432
s_add_u32 s74, s76, 8704
buffer_load_dwordx4 v6, s[40:43], s74 offen  lds
s_add_u32 m0, s77, 26624
s_add_u32 s74, s76, 8960
buffer_load_dwordx4 v6, s[40:43], s74 offen  lds
s_add_u32 m0, s77, 3072
s_add_u32 s74, s76, 12288
buffer_load_dwordx4 v7, s[40:43], s74 offen  lds
s_add_u32 m0, s77, 11264
s_add_u32 s74, s76, 12544
buffer_load_dwordx4 v7, s[40:43], s74 offen  lds
s_add_u32 m0, s77, 19456
s_add_u32 s74, s76, 12800
buffer_load_dwordx4 v7, s[40:43], s74 offen  lds
s_add_u32 m0, s77, 27648
s_add_u32 s74, s76, 13056
buffer_load_dwordx4 v7, s[40:43], s74 offen  lds
s_add_u32 m0, s77, 4096
s_add_u32 s74, s76, 16384
buffer_load_dwordx4 v4, s[40:43], s74 offen  lds
s_add_u32 m0, s77, 12288
s_add_u32 s74, s76, 16640
buffer_load_dwordx4 v4, s[40:43], s74 offen  lds
s_add_u32 m0, s77, 20480
s_add_u32 s74, s76, 16896
buffer_load_dwordx4 v4, s[40:43], s74 offen  lds
s_add_u32 m0, s77, 28672
s_add_u32 s74, s76, 17152
buffer_load_dwordx4 v4, s[40:43], s74 offen  lds
s_add_u32 m0, s77, 5120
s_add_u32 s74, s76, 20480
buffer_load_dwordx4 v5, s[40:43], s74 offen  lds
s_add_u32 m0, s77, 13312
s_add_u32 s74, s76, 20736
buffer_load_dwordx4 v5, s[40:43], s74 offen  lds
s_add_u32 m0, s77, 21504
s_add_u32 s74, s76, 20992
buffer_load_dwordx4 v5, s[40:43], s74 offen  lds
s_add_u32 m0, s77, 29696
s_add_u32 s74, s76, 21248
buffer_load_dwordx4 v5, s[40:43], s74 offen  lds
s_add_u32 m0, s77, 6144
s_add_u32 s74, s76, 24576
buffer_load_dwordx4 v6, s[40:43], s74 offen  lds
s_add_u32 m0, s77, 14336
s_add_u32 s74, s76, 24832
buffer_load_dwordx4 v6, s[40:43], s74 offen  lds
s_add_u32 m0, s77, 22528
s_add_u32 s74, s76, 25088
buffer_load_dwordx4 v6, s[40:43], s74 offen  lds
s_add_u32 m0, s77, 30720
s_add_u32 s74, s76, 25344
buffer_load_dwordx4 v6, s[40:43], s74 offen  lds
s_add_u32 m0, s77, 7168
s_add_u32 s74, s76, 28672
buffer_load_dwordx4 v7, s[40:43], s74 offen  lds
s_add_u32 m0, s77, 15360
s_add_u32 s74, s76, 28928
buffer_load_dwordx4 v7, s[40:43], s74 offen  lds
s_add_u32 m0, s77, 23552
s_add_u32 s74, s76, 29184
buffer_load_dwordx4 v7, s[40:43], s74 offen  lds
s_add_u32 m0, s77, 31744
s_add_u32 s74, s76, 29440
buffer_load_dwordx4 v7, s[40:43], s74 offen  lds
s_branch L_pg_21
.p2align 12
L_pg_7:
v_dot2_f32_bf16 v60, v204, v212, 0
v_dot2_f32_bf16 v61, v208, v212, 0
v_dot2_f32_bf16 v60, v205, v213, v60
v_dot2_f32_bf16 v61, v209, v213, v61
v_dot2_f32_bf16 v60, v206, v214, v60
v_dot2_f32_bf16 v61, v210, v214, v61
v_dot2_f32_bf16 v60, v207, v215, v60
v_dot2_f32_bf16 v61, v211, v215, v61
s_nop 2
v_permlane32_swap_b32 v60, v61
v_add_f32 v202, v60, v61
s_nop 1
v_add_f32_dpp v202, v202, v202 row_ror:8 row_mask:0xf bank_mask:0xf
s_nop 1
v_add_f32_dpp v202, v202, v202 row_ror:4 row_mask:0xf bank_mask:0xf
s_nop 1
v_add_f32_dpp v202, v202, v202 row_ror:2 row_mask:0xf bank_mask:0xf
s_nop 1
v_add_f32_dpp v202, v202, v202 row_ror:1 row_mask:0xf bank_mask:0xf
v_mov_b32 v60, v202
s_nop 1
v_permlane16_swap_b32 v202, v60
v_add_f32_e64 v202, v202, v60
v_mul_f32 v202, 0xbfb8aa3b, v202
v_exp_f32 v202, v202
s_nop 0
v_add_f32 v202, 1.0, v202
v_rcp_f32 v202, v202
s_waitcnt vmcnt(20)
s_barrier
ds_read_b64_tr_b16 v[236:237], v44 offset:0
ds_read_b64_tr_b16 v[238:239], v45 offset:0
ds_read_b64_tr_b16 v[240:241], v44 offset:4096
ds_read_b64_tr_b16 v[242:243], v45 offset:4096
ds_read_b64_tr_b16 v[244:245], v44 offset:8192
ds_read_b64_tr_b16 v[246:247], v45 offset:8192
ds_read_b64_tr_b16 v[248:249], v44 offset:12288
ds_read_b64_tr_b16 v[250:251], v45 offset:12288
s_waitcnt lgkmcnt(6)
v_mfma_f32_16x16x32_bf16 v[160:163], v[20:23], v[236:239], 0
s_waitcnt lgkmcnt(4)
v_mfma_f32_16x16x32_bf16 v[160:163], v[24:27], v[240:243], v[160:163]
s_waitcnt lgkmcnt(2)
v_mfma_f32_16x16x32_bf16 v[160:163], v[28:31], v[244:247], v[160:163]
s_waitcnt lgkmcnt(0)
v_mfma_f32_16x16x32_bf16 v[160:163], v[32:35], v[248:251], v[160:163]
s_lshr_b32 s74, s80, 1
s_add_u32 s74, s74, 327680
s_lshr_b32 s85, s81, 1
s_add_u32 s85, s85, 327680
s_lshr_b32 s86, s82, 1
s_add_u32 s86, s86, 327680
s_lshr_b32 s87, s83, 1
s_add_u32 s87, s87, 327680
s_lshr_b32 s76, s3, 1
s_lshl_b32 s76, s76, 15
s_lshl_b32 s84, s72, 4
s_add_u32 s76, s76, s84
s_add_u32 s76, s76, 196608
v_cndmask_b32 v190, v160, v161, s[90:91]
s_mov_b32 exec_hi, 0
buffer_store_dwordx2 v[190:191], v196, s[32:35], s74 offen sc1
s_mov_b64 exec, -1
v_mov_b32 v203, v190
v_lshlrev_b32 v27, 9, v1
v_and_b32 v58, 15, v1
s_lshl_b32 s74, s3, 4
v_add_u32_e64 v58, s74, v58
v_cmp_gt_u32 s[88:89], 56, v58
v_lshrrev_b32_e64 v59, 4, v1
v_mul_u32_u24 v26, 272, v59
v_lshl_add_u32 v26, v58, 1, v26
v_add_u32 v26, 132096, v26
s_and_b32 s74, s3, 1
s_lshl_b32 s74, s74, 5
v_add_u32 v28, s74, v59
v_lshlrev_b32 v28, 2, v28
s_load_dword s6, s[26:27], 192
v_and_b32 v56, 15, v1
v_lshlrev_b32 v56, 9, v56
v_lshrrev_b32_e64 v57, 4, v1
v_lshl_add_u32 v27, v57, 14, v56
s_lshr_b32 s76, s3, 1
s_lshl_b32 s76, s76, 16
s_lshl_b32 s74, s72, 4
s_add_u32 s76, s76, s74
s_add_u32 s76, s76, 196608
s_mov_b32 s94, 0
s_lshr_b32 s13, s72, 4
s_lshl_b32 s13, s13, 13
s_waitcnt lgkmcnt(0)
s_lshr_b32 s74, s6, 24
s_cmp_eq_u32 s74, 64
s_cbranch_scc0 L_vt_8
L_vt_ok_9:
s_and_b32 s74, s6, 0xffffff
s_cmp_gt_u32 s74, 131072
s_cselect_b32 s9, 8192, 0
s_xor_b32 s9, s9, s13
s_add_u32 s76, s76, s9
s_xor_b32 s78, s78, s9
s_waitcnt vmcnt(0)
s_barrier
buffer_load_dwordx4 v[192:195], v27, s[32:35], s76 offen sc1
ds_read_b64_tr_b16 v[64:65], v40 offset:0
ds_read_b64_tr_b16 v[66:67], v42 offset:0
ds_read_b64_tr_b16 v[68:69], v41 offset:0
ds_read_b64_tr_b16 v[70:71], v43 offset:0
ds_read_b64_tr_b16 v[72:73], v40 offset:8192
ds_read_b64_tr_b16 v[74:75], v42 offset:8192
ds_read_b64_tr_b16 v[76:77], v41 offset:8192
ds_read_b64_tr_b16 v[78:79], v43 offset:8192
ds_read_b64_tr_b16 v[80:81], v40 offset:16384
ds_read_b64_tr_b16 v[82:83], v42 offset:16384
ds_read_b64_tr_b16 v[84:85], v41 offset:16384
ds_read_b64_tr_b16 v[86:87], v43 offset:16384
ds_read_b64_tr_b16 v[88:89], v40 offset:24576
ds_read_b64_tr_b16 v[90:91], v42 offset:24576
ds_read_b64_tr_b16 v[92:93], v41 offset:24576
s_waitcnt lgkmcnt(14)
ds_read_b64_tr_b16 v[94:95], v43 offset:24576
s_waitcnt lgkmcnt(14)
ds_read_b64_tr_b16 v[96:97], v40 offset:32768
s_waitcnt lgkmcnt(14)
ds_read_b64_tr_b16 v[98:99], v42 offset:32768
s_waitcnt lgkmcnt(14)
ds_read_b64_tr_b16 v[100:101], v41 offset:32768
s_waitcnt lgkmcnt(14)
ds_read_b64_tr_b16 v[102:103], v43 offset:32768
s_waitcnt lgkmcnt(14)
ds_read_b64_tr_b16 v[104:105], v40 offset:40960
s_waitcnt lgkmcnt(14)
ds_read_b64_tr_b16 v[106:107], v42 offset:40960
s_waitcnt lgkmcnt(14)
ds_read_b64_tr_b16 v[108:109], v41 offset:40960
s_waitcnt lgkmcnt(14)
ds_read_b64_tr_b16 v[110:111], v43 offset:40960
s_waitcnt lgkmcnt(14)
ds_read_b64_tr_b16 v[112:113], v40 offset:49152
s_waitcnt lgkmcnt(14)
ds_read_b64_tr_b16 v[114:115], v42 offset:49152
s_waitcnt lgkmcnt(14)
ds_read_b64_tr_b16 v[116:117], v41 offset:49152
s_waitcnt lgkmcnt(14)
ds_read_b64_tr_b16 v[118:119], v43 offset:49152
s_waitcnt lgkmcnt(14)
ds_read_b64_tr_b16 v[120:121], v40 offset:57344
s_waitcnt lgkmcnt(14)
ds_read_b64_tr_b16 v[122:123], v42 offset:57344
s_waitcnt lgkmcnt(14)
ds_read_b64_tr_b16 v[124:125], v41 offset:57344
s_waitcnt lgkmcnt(14)
ds_read_b64_tr_b16 v[126:127], v43 offset:57344
s_waitcnt lgkmcnt(14)
ds_read_b64_tr_b16 v[236:237], v36 offset:16384
s_waitcnt lgkmcnt(14)
ds_read_b64_tr_b16 v[238:239], v38 offset:16384
s_waitcnt lgkmcnt(14)
ds_read_b64_tr_b16 v[240:241], v37 offset:16384
s_waitcnt lgkmcnt(14)
ds_read_b64_tr_b16 v[242:243], v39 offset:16384
s_waitcnt lgkmcnt(14)
ds_read_b64_tr_b16 v[244:245], v36 offset:24576
s_waitcnt lgkmcnt(14)
ds_read_b64_tr_b16 v[246:247], v38 offset:24576
s_waitcnt lgkmcnt(14)
ds_read_b64_tr_b16 v[248:249], v37 offset:24576
s_waitcnt lgkmcnt(14)
ds_read_b64_tr_b16 v[250:251], v39 offset:24576
s_mov_b32 s94, 0
s_branch L_st_chk_11
L_st_10:
buffer_load_dwordx4 v[192:195], v27, s[32:35], s76 offen sc1
L_st_chk_11:
s_waitcnt vmcnt(0)
v_cmp_ne_u32 vcc, s30, v194
s_cbranch_vccz L_st_10_ok
s_mov_b64 exec, vcc
s_add_u32 s94, s94, 1
s_cmp_lt_u32 s94, 40000
s_cbranch_scc1 L_st_10
L_st_10_ok:
s_mov_b64 exec, -1
s_barrier
buffer_load_dwordx4 v[128:131], v48, s[32:35], s78 offen sc1
buffer_load_dwordx4 v[132:135], v49, s[32:35], s78 offen sc1
buffer_load_dwordx4 v[136:139], v50, s[32:35], s78 offen sc1
buffer_load_dwordx4 v[140:143], v51, s[32:35], s78 offen sc1
buffer_load_dwordx4 v[144:147], v52, s[32:35], s78 offen sc1
buffer_load_dwordx4 v[148:151], v53, s[32:35], s78 offen sc1
buffer_load_dwordx4 v[152:155], v54, s[32:35], s78 offen sc1
buffer_load_dwordx4 v[156:159], v55, s[32:35], s78 offen sc1
s_mov_b32 exec_hi, 0
buffer_load_dwordx2 v[20:21], v196, s[32:35], s85 offen sc1
buffer_load_dwordx2 v[22:23], v196, s[32:35], s86 offen sc1
buffer_load_dwordx2 v[24:25], v196, s[32:35], s87 offen sc1
s_mov_b64 exec, -1
v_mov_b32_e64 v56, v192
s_nop 1
v_max_f32_dpp v56, v56, v56 row_ror:8 row_mask:0xf bank_mask:0xf
s_nop 1
v_max_f32_dpp v56, v56, v56 row_ror:4 row_mask:0xf bank_mask:0xf
s_nop 1
v_max_f32_dpp v56, v56, v56 row_ror:2 row_mask:0xf bank_mask:0xf
s_nop 1
v_max_f32_dpp v56, v56, v56 row_ror:1 row_mask:0xf bank_mask:0xf
v_mov_b32 v57, v56
s_nop 1
v_permlane16_swap_b32 v56, v57
v_max_f32 v56, v56, v57
v_mov_b32 v57, v56
s_nop 1
v_permlane32_swap_b32 v56, v57
v_max_f32 v56, v56, v57
v_sub_f32 v56, v192, v56
v_exp_f32 v56, v56
s_waitcnt lgkmcnt(0)
v_cvt_pk_bf16_f32 v56, v56, 0
v_lshlrev_b32 v57, 16, v56
v_mul_f32 v57, v57, v193
ds_bpermute_b32 v204, v28, v56 offset:0
ds_bpermute_b32 v205, v28, v56 offset:16
ds_bpermute_b32 v206, v28, v56 offset:32
ds_bpermute_b32 v207, v28, v56 offset:48
ds_bpermute_b32 v208, v28, v56 offset:64
ds_bpermute_b32 v209, v28, v56 offset:80
ds_bpermute_b32 v210, v28, v56 offset:96
ds_bpermute_b32 v211, v28, v56 offset:112
v_add_f32_dpp v57, v57, v57 row_ror:8 row_mask:0xf bank_mask:0xf
s_nop 1
v_add_f32_dpp v57, v57, v57 row_ror:4 row_mask:0xf bank_mask:0xf
s_nop 1
v_add_f32_dpp v57, v57, v57 row_ror:2 row_mask:0xf bank_mask:0xf
s_nop 1
v_add_f32_dpp v57, v57, v57 row_ror:1 row_mask:0xf bank_mask:0xf
v_mov_b32 v58, v57
s_nop 1
v_permlane16_swap_b32 v57, v58
v_add_f32 v57, v57, v58
v_mov_b32 v58, v57
s_nop 1
v_permlane32_swap_b32 v57, v58
v_add_f32 v57, v57, v58
v_rcp_f32_e64 v62, v57
s_waitcnt lgkmcnt(0)
s_lshr_b32 s74, s3, 1
s_lshl_b32 s74, s74, 2
s_add_u32 s74, s74, 134144
v_mov_b32_e64 v60, s74
ds_write_b32 v60, v62
v_lshrrev_b32 v61, 5, v1
v_lshlrev_b32 v61, 2, v61
v_add_u32 v61, 134144, v61
v_lshlrev_b32 v212, 16, v204
v_lshlrev_b32 v213, 16, v205
v_lshlrev_b32 v214, 16, v206
v_lshlrev_b32 v215, 16, v207
v_lshlrev_b32 v216, 16, v208
v_lshlrev_b32 v217, 16, v209
v_lshlrev_b32 v218, 16, v210
v_lshlrev_b32 v219, 16, v211
s_mov_b32 s94, 0
s_waitcnt vmcnt(10)
v_xor_b32 v128, v128, v4
v_xor_b32 v129, v129, v5
v_dot2_f32_bf16 v220, v128, v204, 0
v_dot2_f32_bf16 v221, v128, v212, 0
v_dot2_f32_bf16 v222, v129, v204, 0
v_dot2_f32_bf16 v223, v129, v212, 0
v_dot2_f32_bf16 v224, v130, v204, 0
v_dot2_f32_bf16 v225, v130, v212, 0
v_dot2_f32_bf16 v226, v131, v204, 0
v_dot2_f32_bf16 v227, v131, v212, 0
v_or_b32 v56, v128, v129
s_waitcnt vmcnt(9)
v_xor_b32 v132, v132, v4
v_xor_b32 v133, v133, v5
v_dot2_f32_bf16 v220, v132, v205, v220
v_dot2_f32_bf16 v221, v132, v213, v221
v_dot2_f32_bf16 v222, v133, v205, v222
v_dot2_f32_bf16 v223, v133, v213, v223
v_dot2_f32_bf16 v224, v134, v205, v224
v_dot2_f32_bf16 v225, v134, v213, v225
v_dot2_f32_bf16 v226, v135, v205, v226
v_dot2_f32_bf16 v227, v135, v213, v227
v_or3_b32 v56, v132, v133, v56
s_waitcnt vmcnt(8)
v_xor_b32 v136, v136, v4
v_xor_b32_e64 v137, v137, v5
v_dot2_f32_bf16 v220, v136, v206, v220
v_dot2_f32_bf16 v221, v136, v214, v221
v_dot2_f32_bf16 v222, v137, v206, v222
v_dot2_f32_bf16 v223, v137, v214, v223
v_dot2_f32_bf16 v224, v138, v206, v224
v_dot2_f32_bf16 v225, v138, v214, v225
v_dot2_f32_bf16 v226, v139, v206, v226
v_dot2_f32_bf16 v227, v139, v214, v227
v_or3_b32 v56, v136, v137, v56
s_waitcnt vmcnt(7)
v_xor_b32 v140, v140, v4
v_xor_b32_e64 v141, v141, v5
v_dot2_f32_bf16 v220, v140, v207, v220
v_dot2_f32_bf16 v221, v140, v215, v221
v_dot2_f32_bf16 v222, v141, v207, v222
v_dot2_f32_bf16 v223, v141, v215, v223
v_dot2_f32_bf16 v224, v142, v207, v224
v_dot2_f32_bf16 v225, v142, v215, v225
v_dot2_f32_bf16 v226, v143, v207, v226
v_dot2_f32_bf16 v227, v143, v215, v227
v_or3_b32 v56, v140, v141, v56
s_waitcnt vmcnt(6)
v_xor_b32 v144, v144, v4
v_xor_b32_e64 v145, v145, v5
v_dot2_f32_bf16 v220, v144, v208, v220
v_dot2_f32_bf16 v221, v144, v216, v221
v_dot2_f32_bf16 v222, v145, v208, v222
v_dot2_f32_bf16 v223, v145, v216, v223
v_dot2_f32_bf16 v224, v146, v208, v224
v_dot2_f32_bf16 v225, v146, v216, v225
v_dot2_f32_bf16 v226, v147, v208, v226
v_dot2_f32_bf16 v227, v147, v216, v227
v_or3_b32 v56, v144, v145, v56
s_waitcnt vmcnt(5)
v_xor_b32 v148, v148, v4
v_xor_b32_e64 v149, v149, v5
v_dot2_f32_bf16 v220, v148, v209, v220
v_dot2_f32_bf16 v221, v148, v217, v221
v_dot2_f32_bf16 v222, v149, v209, v222
v_dot2_f32_bf16 v223, v149, v217, v223
v_dot2_f32_bf16 v224, v150, v209, v224
v_dot2_f32_bf16 v225, v150, v217, v225
v_dot2_f32_bf16 v226, v151, v209, v226
v_dot2_f32_bf16 v227, v151, v217, v227
v_or3_b32 v56, v148, v149, v56
s_waitcnt vmcnt(4)
v_xor_b32 v152, v152, v4
v_xor_b32_e64 v153, v153, v5
v_dot2_f32_bf16 v220, v152, v210, v220
v_dot2_f32_bf16 v221, v152, v218, v221
v_dot2_f32_bf16 v222, v153, v210, v222
v_dot2_f32_bf16 v223, v153, v218, v223
v_dot2_f32_bf16 v224, v154, v210, v224
v_dot2_f32_bf16 v225, v154, v218, v225
v_dot2_f32_bf16 v226, v155, v210, v226
v_dot2_f32_bf16 v227, v155, v218, v227
v_or3_b32 v56, v152, v153, v56
s_waitcnt vmcnt(3)
v_xor_b32 v156, v156, v4
v_xor_b32_e64 v157, v157, v5
v_dot2_f32_bf16 v220, v156, v211, v220
v_dot2_f32_bf16 v221, v156, v219, v221
v_dot2_f32_bf16 v222, v157, v211, v222
v_dot2_f32_bf16 v223, v157, v219, v223
v_dot2_f32_bf16 v224, v158, v211, v224
v_dot2_f32_bf16 v225, v158, v219, v225
v_dot2_f32_bf16 v226, v159, v211, v226
v_dot2_f32_bf16 v227, v159, v219, v227
v_or3_b32 v56, v156, v157, v56
v_cvt_pk_bf16_f32 v192, v220, v221
v_cvt_pk_bf16_f32 v193, v222, v223
v_cvt_pk_bf16_f32 v194, v224, v225
v_cvt_pk_bf16_f32 v195, v226, v227
ds_write_b128 v228, v[192:195]
v_and_b32 v56, 0x00010001, v56
v_cmp_ne_u32 vcc, 0, v56
s_cbranch_vccnz L_o_12
L_o_ok_13:
s_waitcnt lgkmcnt(0)
s_barrier
ds_read_b128 v[128:131], v229
ds_read_b128 v[132:135], v230
ds_read_b128 v[136:139], v231
ds_read_b128 v[140:143], v232
ds_read_b32 v62, v61
s_add_u32 s74, s11, s9
s_add_u32 s74, s74, 1048576
s_xor_b32 s13, s74, 0x2000
s_waitcnt lgkmcnt(4)
v_mfma_f32_16x16x32_bf16 v[160:163], v[128:131], v[64:67], 0
v_mfma_f32_16x16x32_bf16 v[164:167], v[128:131], v[68:71], 0
s_waitcnt lgkmcnt(3)
v_mfma_f32_16x16x32_bf16 v[160:163], v[132:135], v[72:75], v[160:163]
v_mfma_f32_16x16x32_bf16 v[164:167], v[132:135], v[76:79], v[164:167]
s_waitcnt lgkmcnt(2)
v_mfma_f32_16x16x32_bf16 v[160:163], v[136:139], v[80:83], v[160:163]
v_mfma_f32_16x16x32_bf16 v[164:167], v[136:139], v[84:87], v[164:167]
s_waitcnt lgkmcnt(1)
v_mfma_f32_16x16x32_bf16 v[160:163], v[140:143], v[88:91], v[160:163]
v_mfma_f32_16x16x32_bf16 v[164:167], v[140:143], v[92:95], v[164:167]
s_nop 6
v_add_f32 v56, v160, v162
v_add_f32 v57, v161, v163
v_add_f32 v58, v164, v166
v_add_f32 v59, v165, v167
s_nop 0
v_permlane16_swap_b32 v56, v58
v_permlane16_swap_b32 v57, v59
v_add_f32 v56, v56, v58
v_add_f32 v57, v57, v59
s_nop 1
v_permlane32_swap_b32 v56, v57
v_add_f32 v190, v56, v57
s_waitcnt lgkmcnt(0)
v_mul_f32 v190, v190, v62
buffer_store_dwordx2 v[190:191], v196, s[32:35], s74 offen sc1
s_mov_b32 exec_hi, 0
s_mov_b32 s94, 0
s_waitcnt vmcnt(1)
v_xor_b32 v56, s30, v21
v_xor_b32 v57, s30, v23
v_xor_b32 v58, s30, v25
v_or3_b32 v56, v56, v57, v58
v_cmp_ne_u32 vcc, 0, v56
s_cbranch_vccnz L_h1b_14
L_h1b_ok_15:
v_add_f32 v56, v203, v20
v_add_f32 v57, v22, v24
v_add_f32_e64 v56, v56, v57
v_mul_f32 v57, 0xbfb8aa3b, v56
v_exp_f32 v57, v57
s_nop 0
v_add_f32 v57, 1.0, v57
v_rcp_f32 v57, v57
s_nop 0
v_mul_f32 v56, v56, v57
v_cndmask_b32 v56, 0, v56, s[88:89]
v_cvt_pk_bf16_f32 v56, v56, v56
ds_write_b16 v26, v56
s_mov_b64 exec, -1
s_add_u32 s74, s10, s9
s_add_u32 s74, s74, 1048576
s_add_u32 s84, s73, 1
s_and_b32 s84, s84, 3
s_lshl_b32 s84, s84, 11
s_add_u32 s85, s84, s74
s_add_u32 s84, s73, 2
s_and_b32 s84, s84, 3
s_lshl_b32 s84, s84, 11
s_add_u32 s86, s84, s74
s_add_u32 s84, s73, 3
s_and_b32 s84, s84, 3
s_lshl_b32 s84, s84, 11
s_add_u32 s87, s84, s74
s_waitcnt vmcnt(0)
buffer_load_dwordx2 v[184:185], v196, s[32:35], s85 offen sc1
buffer_load_dwordx2 v[186:187], v196, s[32:35], s86 offen sc1
buffer_load_dwordx2 v[188:189], v196, s[32:35], s87 offen sc1
s_waitcnt lgkmcnt(0)
s_barrier
ds_read_b128 v[144:147], v199 offset:1024
ds_read_b128 v[148:151], v199 offset:1088
s_waitcnt lgkmcnt(1)
v_mfma_f32_16x16x32_bf16 v[176:179], v[144:147], v[236:239], 0
v_mfma_f32_16x16x32_bf16 v[180:183], v[144:147], v[240:243], 0
s_waitcnt lgkmcnt(0)
v_mfma_f32_16x16x32_bf16 v[176:179], v[148:151], v[244:247], v[176:179]
v_mfma_f32_16x16x32_bf16 v[180:183], v[148:151], v[248:251], v[180:183]
v_sub_f32_e64 v63, 1.0, v202
s_nop 6
v_cndmask_b32 v56, v176, v180, s[90:91]
v_cndmask_b32 v57, v177, v181, s[90:91]
v_cndmask_b32 v176, v56, v57, s[92:93]
v_mul_f32 v176, v176, v63
s_mov_b32 s94, 0
s_waitcnt vmcnt(0)
v_xor_b32 v56, s30, v185
v_xor_b32 v57, s30, v187
v_xor_b32 v58, s30, v189
v_or3_b32 v56, v56, v57, v58
v_cmp_ne_u32 vcc, 0, v56
s_cbranch_vccz L_h4_ok_17
L_h4_16:
buffer_load_dwordx2 v[184:185], v196, s[32:35], s85 offen sc1
buffer_load_dwordx2 v[186:187], v196, s[32:35], s86 offen sc1
buffer_load_dwordx2 v[188:189], v196, s[32:35], s87 offen sc1
s_waitcnt vmcnt(0)
v_xor_b32 v56, s30, v185
v_xor_b32 v57, s30, v187
v_xor_b32 v58, s30, v189
v_or3_b32 v56, v56, v57, v58
v_cmp_ne_u32 vcc, 0, v56
s_cbranch_vccz L_h4_ok_17
s_add_u32 s94, s94, 1
s_cmp_lt_u32 s94, 40000
s_cbranch_scc1 L_h4_16
L_h4_ok_17:
v_add_f32 v56, v190, v184
v_add_f32 v57, v186, v188
v_add_f32_e64 v56, v56, v57
v_cvt_pk_bf16_f32 v56, v56, v56
ds_write_b16 v198, v56 offset:2048
s_waitcnt lgkmcnt(0)
s_barrier
ds_read_b128 v[128:131], v199 offset:2048
ds_read_b128 v[132:135], v199 offset:2112
ds_read_b128 v[136:139], v199 offset:2176
ds_read_b128 v[140:143], v199 offset:2240
s_lshr_b32 s13, s3, 1
s_lshr_b32 s74, s72, 4
s_xor_b32 s13, s13, s74
s_lshl_b32 s13, s13, 13
s_xor_b32 s13, s13, s9
s_add_u32 s74, s11, s13
s_add_u32 s74, s74, 1572864
s_xor_b32 s13, s74, 0x2000
s_waitcnt lgkmcnt(3)
v_mfma_f32_16x16x32_bf16 v[160:163], v[128:131], v[96:99], 0
v_mfma_f32_16x16x32_bf16 v[164:167], v[128:131], v[100:103], 0
s_waitcnt lgkmcnt(2)
v_mfma_f32_16x16x32_bf16 v[160:163], v[132:135], v[104:107], v[160:163]
v_mfma_f32_16x16x32_bf16 v[164:167], v[132:135], v[108:111], v[164:167]
s_waitcnt lgkmcnt(1)
v_mfma_f32_16x16x32_bf16 v[160:163], v[136:139], v[112:115], v[160:163]
v_mfma_f32_16x16x32_bf16 v[164:167], v[136:139], v[116:119], v[164:167]
s_waitcnt lgkmcnt(0)
v_mfma_f32_16x16x32_bf16 v[160:163], v[140:143], v[120:123], v[160:163]
v_mfma_f32_16x16x32_bf16 v[164:167], v[140:143], v[124:127], v[164:167]
v_lshrrev_b32 v58, 2, v1
v_lshlrev_b32 v58, 13, v58
v_and_b32_e64 v62, 3, v1
v_lshl_add_u32 v63, v62, 4, v58
s_lshl_b32 s84, s73, 11
s_and_b32 s76, s72, 7
s_lshl_b32 s76, s76, 6
s_lshr_b32 s85, s72, 3
s_lshl_b32 s85, s85, 9
s_add_u32 s76, s76, s85
s_add_u32 s84, s84, s76
s_add_u32 s84, s84, 1572864
s_add_u32 s85, s84, 131072
v_lshrrev_b32 v58, 2, v1
v_lshlrev_b32_e64 v58, 14, v58
v_lshl_add_u32 v63, v62, 4, v58
s_lshl_b32 s84, s73, 11
s_lshl_b32 s76, s72, 6
s_add_u32 s84, s84, s76
s_add_u32 s84, s84, s9
s_add_u32 s84, s84, 1572864
s_add_u32 s85, s84, 262144
v_cndmask_b32 v56, v160, v164, s[90:91]
v_cndmask_b32 v57, v161, v165, s[90:91]
v_cndmask_b32 v190, v56, v57, s[92:93]
v_fma_f32 v190, v190, v202, v176
buffer_store_dwordx2 v[190:191], v196, s[32:35], s74 offen sc1
s_cmp_lg_u32 s3, 0
s_cbranch_scc1 L_bump
s_lshr_b32 s74, s72, 2
s_and_b32 s74, s74, 1
s_lshl_b32 s74, s74, 10
s_lshl_b32 s76, s73, 8
s_add_u32 s74, s74, s76
s_lshr_b32 s76, s72, 3
s_lshl_b32 s76, s76, 6
s_add_u32 s74, s74, s76
s_and_b32 s76, s72, 3
s_lshl_b32 s76, s76, 4
s_add_u32 s74, s74, s76
v_lshlrev_b32 v62, 2, v62
s_waitcnt vmcnt(0)
s_mov_b32 s94, 0
L_h5_18:
buffer_load_dwordx4 v[128:131], v63, s[32:35], s84 offen sc1
buffer_load_dwordx4 v[132:135], v63, s[32:35], s85 offen sc1
s_waitcnt vmcnt(0)
L_h5_chk_19:
v_xor_b32 v56, s30, v129
v_xor_b32 v58, s30, v131
v_xor_b32 v59, s30, v133
v_xor_b32_e64 v60, s30, v135
v_or3_b32 v56, v56, v58, v59
v_or_b32_e64 v56, v56, v60
v_cmp_ne_u32 vcc, 0, v56
s_cbranch_vccz L_h5_18_ok
s_mov_b64 exec, vcc
s_add_u32 s94, s94, 1
s_cmp_lt_u32 s94, 40000
s_cbranch_scc1 L_h5_18
L_h5_18_ok:
s_mov_b64 exec, -1
v_add_f32 v56, v128, v132
v_add_f32 v58, v130, v134
s_nop 1
v_permlane32_swap_b32 v56, v58
v_add_f32 v56, v56, v58
s_nop 1
v_add_f32_dpp v56, v56, v56 row_ror:8 row_mask:0xf bank_mask:0xf
s_nop 1
v_add_f32_dpp v56, v56, v56 row_ror:4 row_mask:0xf bank_mask:0xf
v_mov_b32 v58, v56
s_nop 1
v_permlane16_swap_b32 v56, v58
v_add_f32 v56, v56, v58
v_mov_b32 v58, v56
s_nop 1
v_permlane32_swap_b32 v56, v58
v_cvt_pk_bf16_f32 v56, v56, v58
s_mov_b64 exec, 15
buffer_store_dword v56, v62, s[68:71], s74 offen
L_ft_end:
s_endpgm
.p2align 12
L_pg_21:
s_waitcnt vmcnt(16) lgkmcnt(0)
s_barrier
s_waitcnt vmcnt(8)
buffer_load_dwordx4 v[68:71], v16, s[32:35], s78 offen offset:0 sc1
buffer_load_dwordx4 v[72:75], v16, s[32:35], s78 offen offset:128 sc1
buffer_load_dwordx4 v[76:79], v16, s[32:35], s78 offen offset:256 sc1
buffer_load_dwordx4 v[80:83], v16, s[32:35], s78 offen offset:384 sc1
buffer_load_dwordx4 v[84:87], v16, s[32:35], s78 offen offset:512 sc1
buffer_load_dwordx4 v[88:91], v16, s[32:35], s78 offen offset:640 sc1
buffer_load_dwordx4 v[92:95], v16, s[32:35], s78 offen offset:768 sc1
buffer_load_dwordx4 v[96:99], v16, s[32:35], s78 offen offset:896 sc1
buffer_load_dwordx4 v[100:103], v16, s[32:35], s78 offen offset:1024 sc1
buffer_load_dwordx4 v[104:107], v16, s[32:35], s78 offen offset:1152 sc1
buffer_load_dwordx4 v[108:111], v16, s[32:35], s78 offen offset:1280 sc1
buffer_load_dwordx4 v[112:115], v16, s[32:35], s78 offen offset:1408 sc1
s_waitcnt vmcnt(12)
ds_read_b128 a[128:131], v28 offset:0
ds_read_b128 a[132:135], v29 offset:0
ds_read_b128 a[136:139], v30 offset:0
ds_read_b128 a[140:143], v31 offset:0
ds_read_b128 a[144:147], v32 offset:0
ds_read_b128 a[148:151], v33 offset:0
ds_read_b128 a[152:155], v34 offset:0
ds_read_b128 a[156:159], v35 offset:0
ds_read_b128 a[160:163], v28 offset:8192
ds_read_b128 a[164:167], v29 offset:8192
ds_read_b128 a[168:171], v30 offset:8192
ds_read_b128 a[172:175], v31 offset:8192
ds_read_b128 a[176:179], v32 offset:8192
ds_read_b128 a[180:183], v33 offset:8192
ds_read_b128 a[184:187], v34 offset:8192
s_waitcnt lgkmcnt(14)
ds_read_b128 a[188:191], v35 offset:8192
s_waitcnt lgkmcnt(14)
ds_read_b128 a[192:195], v28 offset:16384
s_waitcnt lgkmcnt(14)
ds_read_b128 a[196:199], v29 offset:16384
s_waitcnt lgkmcnt(14)
ds_read_b128 a[200:203], v30 offset:16384
s_waitcnt lgkmcnt(14)
ds_read_b128 a[204:207], v31 offset:16384
s_waitcnt lgkmcnt(14)
ds_read_b128 a[208:211], v32 offset:16384
s_waitcnt lgkmcnt(14)
ds_read_b128 a[212:215], v33 offset:16384
s_waitcnt lgkmcnt(14)
ds_read_b128 a[216:219], v34 offset:16384
s_waitcnt lgkmcnt(14)
ds_read_b128 a[220:223], v35 offset:16384
s_waitcnt lgkmcnt(14)
ds_read_b128 a[224:227], v28 offset:24576
s_waitcnt lgkmcnt(14)
ds_read_b128 a[228:231], v29 offset:24576
s_waitcnt lgkmcnt(14)
ds_read_b128 a[232:235], v30 offset:24576
s_waitcnt lgkmcnt(14)
ds_read_b128 a[236:239], v31 offset:24576
s_waitcnt lgkmcnt(14)
ds_read_b128 a[240:243], v32 offset:24576
s_waitcnt lgkmcnt(14)
ds_read_b128 a[244:247], v33 offset:24576
s_waitcnt lgkmcnt(14)
ds_read_b128 a[248:251], v34 offset:24576
s_waitcnt lgkmcnt(14)
ds_read_b128 a[252:255], v35 offset:24576
s_mov_b32 s60, 2097152
s_mov_b32 s64, 2097152
s_mov_b32 s61, 2359296
s_mov_b32 s65, 2359296
s_mov_b32 s62, 2621440
s_mov_b32 s66, 2621440
s_mov_b32 s63, 2883584
s_mov_b32 s67, 2883584
s_mov_b32 s94, 0
s_waitcnt vmcnt(9)
v_min3_u32 v8, v71, v75, v79
v_max3_u32 v9, v71, v75, v79
v_mov_b32 v71, v76
v_mov_b32 v75, v77
s_waitcnt lgkmcnt(14)
ds_write_b128 v17, v[68:71] offset:0
s_waitcnt lgkmcnt(14)
ds_write_b128 v17, v[72:75] offset:512
s_waitcnt vmcnt(6)
v_min3_u32 v8, v8, v83, v87
v_max3_u32 v9, v9, v83, v87
v_mov_b32 v83, v88
v_mov_b32_e64 v87, v89
s_waitcnt lgkmcnt(14)
ds_write_b128 v17, v[80:83] offset:8192
s_waitcnt lgkmcnt(14)
ds_write_b128 v17, v[84:87] offset:8704
v_min_u32 v8, v8, v91
v_max_u32 v9, v9, v91
s_waitcnt vmcnt(3)
v_min3_u32 v8, v8, v95, v99
v_max3_u32 v9, v9, v95, v99
v_mov_b32 v95, v100
v_mov_b32_e64 v99, v101
s_waitcnt lgkmcnt(14)
ds_write_b128 v17, v[92:95] offset:16384
s_waitcnt lgkmcnt(14)
ds_write_b128 v17, v[96:99] offset:16896
v_min_u32 v8, v8, v103
v_max_u32 v9, v9, v103
s_waitcnt vmcnt(0)
v_min3_u32 v8, v8, v107, v111
v_max3_u32 v9, v9, v107, v111
v_mov_b32 v107, v112
v_mov_b32_e64 v111, v113
s_waitcnt lgkmcnt(14)
ds_write_b128 v17, v[104:107] offset:24576
s_waitcnt lgkmcnt(14)
ds_write_b128 v17, v[108:111] offset:25088
v_min_u32 v8, v8, v115
v_max_u32 v9, v9, v115
v_xor_b32 v8, s30, v8
v_xor_b32 v9, s30, v9
v_or_b32 v8, v8, v9
v_cmp_ne_u32 vcc, 0, v8
s_cbranch_vccnz L_q_23
L_q_ok_24:
s_waitcnt lgkmcnt(0)
s_barrier
ds_read_b128 v[116:119], v20 offset:0
ds_read_b128 v[120:123], v21 offset:0
ds_read_b128 v[124:127], v22 offset:0
ds_read_b128 v[128:131], v23 offset:0
s_waitcnt lgkmcnt(3)
v_mfma_f32_32x32x16_bf16 v[148:163], a[128:131], v[116:119], 0
ds_read_b64_tr_b16 a[0:1], v36 offset:0
ds_read_b64_tr_b16 a[2:3], v44 offset:0
ds_read_b128 v[132:135], v24 offset:0
s_waitcnt lgkmcnt(5)
v_mfma_f32_32x32x16_bf16 v[148:163], a[132:135], v[120:123], v[148:163]
ds_read_b64_tr_b16 a[4:5], v36 offset:32768
ds_read_b64_tr_b16 a[6:7], v44 offset:32768
ds_read_b128 v[136:139], v25 offset:0
s_waitcnt lgkmcnt(7)
v_mfma_f32_32x32x16_bf16 v[148:163], a[136:139], v[124:127], v[148:163]
ds_read_b64_tr_b16 a[8:9], v52 offset:0
ds_read_b64_tr_b16 a[10:11], v60 offset:0
ds_read_b128 v[140:143], v26 offset:0
s_waitcnt lgkmcnt(9)
v_mfma_f32_32x32x16_bf16 v[148:163], a[140:143], v[128:131], v[148:163]
ds_read_b64_tr_b16 a[12:13], v52 offset:32768
ds_read_b64_tr_b16 a[14:15], v60 offset:32768
ds_read_b128 v[144:147], v27 offset:0
s_waitcnt lgkmcnt(9)
v_mfma_f32_32x32x16_bf16 v[148:163], a[144:147], v[132:135], v[148:163]
ds_read_b64_tr_b16 a[16:17], v37 offset:0
ds_read_b64_tr_b16 a[18:19], v45 offset:0
ds_read_b128 v[116:119], v20 offset:8192
s_waitcnt lgkmcnt(9)
v_mfma_f32_32x32x16_bf16 v[148:163], a[148:151], v[136:139], v[148:163]
ds_read_b64_tr_b16 a[20:21], v37 offset:32768
ds_read_b64_tr_b16 a[22:23], v45 offset:32768
ds_read_b128 v[120:123], v21 offset:8192
s_waitcnt lgkmcnt(9)
v_mfma_f32_32x32x16_bf16 v[148:163], a[152:155], v[140:143], v[148:163]
ds_read_b64_tr_b16 a[24:25], v53 offset:0
ds_read_b64_tr_b16 a[26:27], v61 offset:0
ds_read_b128 v[124:127], v22 offset:8192
s_waitcnt lgkmcnt(9)
v_mfma_f32_32x32x16_bf16 v[148:163], a[156:159], v[144:147], v[148:163]
ds_read_b64_tr_b16 a[28:29], v53 offset:32768
ds_read_b64_tr_b16 a[30:31], v61 offset:32768
ds_read_b128 v[128:131], v23 offset:8192
s_waitcnt lgkmcnt(9)
v_mfma_f32_32x32x16_bf16 v[148:163], a[160:163], v[116:119], v[148:163]
ds_read_b64_tr_b16 a[32:33], v38 offset:0
ds_read_b64_tr_b16 a[34:35], v46 offset:0
ds_read_b128 v[132:135], v24 offset:8192
s_waitcnt lgkmcnt(9)
v_mfma_f32_32x32x16_bf16 v[148:163], a[164:167], v[120:123], v[148:163]
ds_read_b64_tr_b16 a[36:37], v38 offset:32768
ds_read_b64_tr_b16 a[38:39], v46 offset:32768
ds_read_b128 v[136:139], v25 offset:8192
s_waitcnt lgkmcnt(9)
v_mfma_f32_32x32x16_bf16 v[148:163], a[168:171], v[124:127], v[148:163]
ds_read_b64_tr_b16 a[40:41], v54 offset:0
ds_read_b64_tr_b16 a[42:43], v62 offset:0
ds_read_b128 v[140:143], v26 offset:8192
s_waitcnt lgkmcnt(9)
v_mfma_f32_32x32x16_bf16 v[148:163], a[172:175], v[128:131], v[148:163]
ds_read_b64_tr_b16 a[44:45], v54 offset:32768
ds_read_b64_tr_b16 a[46:47], v62 offset:32768
ds_read_b128 v[144:147], v27 offset:8192
s_waitcnt lgkmcnt(9)
v_mfma_f32_32x32x16_bf16 v[148:163], a[176:179], v[132:135], v[148:163]
ds_read_b64_tr_b16 a[48:49], v39 offset:0
ds_read_b64_tr_b16 a[50:51], v47 offset:0
ds_read_b128 v[116:119], v20 offset:16384
s_waitcnt lgkmcnt(9)
v_mfma_f32_32x32x16_bf16 v[148:163], a[180:183], v[136:139], v[148:163]
ds_read_b64_tr_b16 a[52:53], v39 offset:32768
ds_read_b64_tr_b16 a[54:55], v47 offset:32768
ds_read_b128 v[120:123], v21 offset:16384
s_waitcnt lgkmcnt(9)
v_mfma_f32_32x32x16_bf16 v[148:163], a[184:187], v[140:143], v[148:163]
ds_read_b64_tr_b16 a[56:57], v55 offset:0
ds_read_b64_tr_b16 a[58:59], v63 offset:0
ds_read_b128 v[124:127], v22 offset:16384
s_waitcnt lgkmcnt(9)
v_mfma_f32_32x32x16_bf16 v[148:163], a[188:191], v[144:147], v[148:163]
ds_read_b64_tr_b16 a[60:61], v55 offset:32768
ds_read_b64_tr_b16 a[62:63], v63 offset:32768
ds_read_b128 v[128:131], v23 offset:16384
s_waitcnt lgkmcnt(9)
v_mfma_f32_32x32x16_bf16 v[148:163], a[192:195], v[116:119], v[148:163]
ds_read_b64_tr_b16 a[64:65], v40 offset:0
ds_read_b64_tr_b16 a[66:67], v48 offset:0
ds_read_b128 v[132:135], v24 offset:16384
s_waitcnt lgkmcnt(9)
v_mfma_f32_32x32x16_bf16 v[148:163], a[196:199], v[120:123], v[148:163]
ds_read_b64_tr_b16 a[68:69], v40 offset:32768
ds_read_b64_tr_b16 a[70:71], v48 offset:32768
ds_read_b128 v[136:139], v25 offset:16384
s_waitcnt lgkmcnt(9)
v_mfma_f32_32x32x16_bf16 v[148:163], a[200:203], v[124:127], v[148:163]
ds_read_b64_tr_b16 a[72:73], v56 offset:0
ds_read_b64_tr_b16 a[74:75], v64 offset:0
ds_read_b128 v[140:143], v26 offset:16384
s_waitcnt lgkmcnt(9)
v_mfma_f32_32x32x16_bf16 v[148:163], a[204:207], v[128:131], v[148:163]
ds_read_b64_tr_b16 a[76:77], v56 offset:32768
ds_read_b64_tr_b16 a[78:79], v64 offset:32768
ds_read_b128 v[144:147], v27 offset:16384
s_waitcnt lgkmcnt(9)
v_mfma_f32_32x32x16_bf16 v[148:163], a[208:211], v[132:135], v[148:163]
ds_read_b64_tr_b16 a[80:81], v41 offset:0
ds_read_b64_tr_b16 a[82:83], v49 offset:0
s_barrier
ds_read_b128 v[116:119], v20 offset:24576
s_waitcnt lgkmcnt(9)
v_mfma_f32_32x32x16_bf16 v[148:163], a[212:215], v[136:139], v[148:163]
ds_read_b64_tr_b16 a[84:85], v41 offset:32768
ds_read_b64_tr_b16 a[86:87], v49 offset:32768
ds_read_b128 v[120:123], v21 offset:24576
s_waitcnt lgkmcnt(9)
v_mfma_f32_32x32x16_bf16 v[148:163], a[216:219], v[140:143], v[148:163]
ds_read_b64_tr_b16 a[88:89], v57 offset:0
ds_read_b64_tr_b16 a[90:91], v65 offset:0
ds_read_b128 v[124:127], v22 offset:24576
s_waitcnt lgkmcnt(9)
v_mfma_f32_32x32x16_bf16 v[148:163], a[220:223], v[144:147], v[148:163]
ds_read_b64_tr_b16 a[92:93], v57 offset:32768
ds_read_b64_tr_b16 a[94:95], v65 offset:32768
ds_read_b128 v[128:131], v23 offset:24576
s_waitcnt lgkmcnt(9)
v_mfma_f32_32x32x16_bf16 v[148:163], a[224:227], v[116:119], v[148:163]
ds_read_b64_tr_b16 a[96:97], v42 offset:0
ds_read_b64_tr_b16 a[98:99], v50 offset:0
ds_read_b128 v[132:135], v24 offset:24576
s_waitcnt lgkmcnt(9)
v_mfma_f32_32x32x16_bf16 v[148:163], a[228:231], v[120:123], v[148:163]
ds_read_b64_tr_b16 a[100:101], v42 offset:32768
ds_read_b64_tr_b16 a[102:103], v50 offset:32768
ds_read_b128 v[136:139], v25 offset:24576
s_waitcnt lgkmcnt(9)
v_mfma_f32_32x32x16_bf16 v[148:163], a[232:235], v[124:127], v[148:163]
ds_read_b64_tr_b16 a[104:105], v58 offset:0
ds_read_b64_tr_b16 a[106:107], v66 offset:0
ds_read_b128 v[140:143], v26 offset:24576
s_waitcnt lgkmcnt(9)
v_mfma_f32_32x32x16_bf16 v[148:163], a[236:239], v[128:131], v[148:163]
ds_read_b64_tr_b16 a[108:109], v58 offset:32768
ds_read_b64_tr_b16 a[110:111], v66 offset:32768
ds_read_b128 v[144:147], v27 offset:24576
s_waitcnt lgkmcnt(9)
v_mfma_f32_32x32x16_bf16 v[148:163], a[240:243], v[132:135], v[148:163]
ds_read_b64_tr_b16 a[112:113], v43 offset:0
ds_read_b64_tr_b16 a[114:115], v51 offset:0
s_waitcnt lgkmcnt(8)
v_mfma_f32_32x32x16_bf16 v[148:163], a[244:247], v[136:139], v[148:163]
ds_read_b64_tr_b16 a[116:117], v43 offset:32768
ds_read_b64_tr_b16 a[118:119], v51 offset:32768
s_waitcnt lgkmcnt(7)
v_mfma_f32_32x32x16_bf16 v[148:163], a[248:251], v[140:143], v[148:163]
ds_read_b64_tr_b16 a[120:121], v59 offset:0
ds_read_b64_tr_b16 a[122:123], v67 offset:0
s_waitcnt lgkmcnt(6)
v_mfma_f32_32x32x16_bf16 v[148:163], a[252:255], v[144:147], v[148:163]
ds_read_b64_tr_b16 a[124:125], v59 offset:32768
ds_read_b64_tr_b16 a[126:127], v67 offset:32768
s_nop 9
v_max3_f32 v8, v148, v149, v150
v_max3_f32 v9, v151, v152, v153
v_max3_f32 v10, v154, v155, v156
v_max3_f32 v11, v157, v158, v159
v_max3_f32 v8, v8, v160, v161
v_max3_f32 v9, v9, v162, v163
v_max3_f32 v8, v8, v10, v11
v_max_f32 v8, v8, v9
v_mov_b32 v9, v8
s_nop 1
v_permlane32_swap_b32 v8, v9
v_max_f32_e64 v8, v8, v9
ds_write_b32 v236, v8
v_mov_b32_e64 v9, v8
v_pk_add_f32 v[148:149], v[148:149], v[8:9] neg_lo:[0,1] neg_hi:[0,1]
v_pk_add_f32 v[150:151], v[150:151], v[8:9] neg_lo:[0,1] neg_hi:[0,1]
v_exp_f32_e64 v148, v148
v_pk_add_f32 v[152:153], v[152:153], v[8:9] neg_lo:[0,1] neg_hi:[0,1]
v_exp_f32_e64 v149, v149
v_pk_add_f32 v[154:155], v[154:155], v[8:9] neg_lo:[0,1] neg_hi:[0,1]
v_exp_f32_e64 v150, v150
v_pk_add_f32 v[156:157], v[156:157], v[8:9] neg_lo:[0,1] neg_hi:[0,1]
v_exp_f32_e64 v151, v151
v_pk_add_f32 v[158:159], v[158:159], v[8:9] neg_lo:[0,1] neg_hi:[0,1]
v_exp_f32_e64 v152, v152
v_pk_add_f32 v[160:161], v[160:161], v[8:9] neg_lo:[0,1] neg_hi:[0,1]
v_pk_add_f32 v[162:163], v[162:163], v[8:9] neg_lo:[0,1] neg_hi:[0,1]
v_exp_f32_e64 v153, v153
s_waitcnt lgkmcnt(0)
s_barrier
ds_read2_b32 v[12:13], v233 offset0:0 offset1:32
ds_read2_b32 v[14:15], v233 offset0:64 offset1:96
v_exp_f32 v154, v154
v_exp_f32 v155, v155
v_xor_b32 v11, 16, v228
v_exp_f32 v156, v156
v_exp_f32 v157, v157
v_exp_f32_e64 v158, v158
s_waitcnt lgkmcnt(0)
v_max3_f32 v237, v12, v13, v14
v_max_f32 v237, v237, v15
v_exp_f32 v159, v159
v_sub_f32 v8, v8, v237
v_exp_f32 v8, v8
v_exp_f32 v160, v160
v_mov_b32 v9, v8
s_load_dword s50, s[26:27], 192
v_pk_mul_f32 v[148:149], v[148:149], v[8:9]
v_pk_mul_f32 v[150:151], v[150:151], v[8:9]
v_exp_f32_e64 v161, v161
v_pk_mul_f32 v[152:153], v[152:153], v[8:9]
v_pk_mul_f32 v[154:155], v[154:155], v[8:9]
v_cvt_pk_bf16_f32 v100, v148, v149
v_exp_f32_e64 v162, v162
v_cvt_pk_bf16_f32 v101, v150, v151
v_cvt_pk_bf16_f32 v102, v152, v153
v_cvt_pk_bf16_f32 v103, v154, v155
v_exp_f32_e64 v163, v163
ds_write_b128 v228, v[100:103]
v_pk_mul_f32 v[156:157], v[156:157], v[8:9]
v_pk_mul_f32 v[158:159], v[158:159], v[8:9]
v_pk_mul_f32 v[160:161], v[160:161], v[8:9]
v_cvt_pk_bf16_f32 v104, v156, v157
v_cvt_pk_bf16_f32 v105, v158, v159
v_pk_mul_f32 v[162:163], v[162:163], v[8:9]
v_cvt_pk_bf16_f32 v106, v160, v161
v_cvt_pk_bf16_f32 v107, v162, v163
ds_write_b128 v11, v[104:107]
v_pk_add_f32 v[148:149], v[148:149], v[156:157]
v_pk_add_f32 v[150:151], v[150:151], v[158:159]
v_pk_add_f32 v[152:153], v[152:153], v[160:161]
v_pk_add_f32 v[154:155], v[154:155], v[162:163]
v_pk_add_f32 v[148:149], v[148:149], v[152:153]
v_pk_add_f32 v[150:151], v[150:151], v[154:155]
v_pk_add_f32 v[148:149], v[148:149], v[150:151]
v_add_f32 v148, v148, v149
v_mov_b32 v149, v148
s_nop 1
v_permlane32_swap_b32 v148, v149
v_add_f32_e64 v148, v148, v149
s_waitcnt lgkmcnt(0)
s_barrier
ds_read_b128 v[68:71], v229 offset:0
ds_read_b128 v[72:75], v230 offset:0
ds_read_b128 v[76:79], v231 offset:0
ds_read_b128 v[80:83], v232 offset:0
ds_read_b128 v[84:87], v229 offset:4096
ds_read_b128 v[88:91], v230 offset:4096
ds_read_b128 v[92:95], v231 offset:4096
ds_read_b128 v[96:99], v232 offset:4096
ds_write_b32 v236, v148 offset:512
s_waitcnt lgkmcnt(8)
v_mfma_f32_16x16x32_bf16 v[164:167], v[68:71], a[0:3], 0
s_mov_b32 s94, 0
s_lshr_b32 s74, s50, 24
s_waitcnt lgkmcnt(7)
v_mfma_f32_16x16x32_bf16 v[164:167], v[72:75], a[4:7], v[164:167]
s_cmp_eq_u32 s74, 64
s_cbranch_scc0 L_avt_25
L_avt_ok_26:
s_waitcnt lgkmcnt(6)
v_mfma_f32_16x16x32_bf16 v[164:167], v[76:79], a[8:11], v[164:167]
s_and_b32 s74, s50, 0xffffff
s_cmp_gt_u32 s74, 131072
s_cselect_b32 s74, 8192, 0
s_waitcnt lgkmcnt(5)
v_mfma_f32_16x16x32_bf16 v[164:167], v[80:83], a[12:15], v[164:167]
v_xor_b32_e64 v234, s74, v234
v_mfma_f32_16x16x32_bf16 v[168:171], v[68:71], a[16:19], 0
v_xor_b32_e64 v28, 0, v234
v_mfma_f32_16x16x32_bf16 v[168:171], v[72:75], a[20:23], v[168:171]
v_xor_b32 v29, 1024, v234
v_mfma_f32_16x16x32_bf16 v[168:171], v[76:79], a[24:27], v[168:171]
v_xor_b32 v30, 2048, v234
v_mfma_f32_16x16x32_bf16 v[168:171], v[80:83], a[28:31], v[168:171]
v_xor_b32 v31, 3072, v234
v_mfma_f32_16x16x32_bf16 v[172:175], v[68:71], a[32:35], 0
s_waitcnt lgkmcnt(0)
s_barrier
ds_read2_b32 v[244:245], v233 offset0:128 offset1:160
ds_read2_b32 v[246:247], v233 offset0:192 offset1:224
v_mfma_f32_16x16x32_bf16 v[172:175], v[72:75], a[36:39], v[172:175]
v_xor_b32 v32, 40960, v234
v_mfma_f32_16x16x32_bf16 v[172:175], v[76:79], a[40:43], v[172:175]
v_xor_b32 v33, 41984, v234
v_xor_b32 v34, 43008, v234
v_mfma_f32_16x16x32_bf16 v[172:175], v[80:83], a[44:47], v[172:175]
v_xor_b32 v35, 44032, v234
v_mfma_f32_16x16x32_bf16 v[176:179], v[68:71], a[48:51], 0
v_cvt_pk_bf16_f32 v100, v164, v168
v_mfma_f32_16x16x32_bf16 v[176:179], v[72:75], a[52:55], v[176:179]
v_cvt_pk_bf16_f32 v104, v165, v169
v_mfma_f32_16x16x32_bf16 v[176:179], v[76:79], a[56:59], v[176:179]
v_cvt_pk_bf16_f32 v108, v166, v170
v_mfma_f32_16x16x32_bf16 v[176:179], v[80:83], a[60:63], v[176:179]
v_cvt_pk_bf16_f32 v112, v167, v171
v_mfma_f32_16x16x32_bf16 v[180:183], v[68:71], a[64:67], 0
v_bfi_b32 v100, s83, v240, v100
v_mfma_f32_16x16x32_bf16 v[180:183], v[72:75], a[68:71], v[180:183]
v_bfi_b32 v104, s83, v240, v104
v_mfma_f32_16x16x32_bf16 v[180:183], v[76:79], a[72:75], v[180:183]
v_bfi_b32 v108, s83, v240, v108
v_mfma_f32_16x16x32_bf16 v[180:183], v[80:83], a[76:79], v[180:183]
v_bfi_b32 v112, s83, v240, v112
v_mfma_f32_16x16x32_bf16 v[184:187], v[68:71], a[80:83], 0
v_cvt_pk_bf16_f32 v101, v172, v176
v_mfma_f32_16x16x32_bf16 v[184:187], v[72:75], a[84:87], v[184:187]
v_cvt_pk_bf16_f32 v105, v173, v177
v_mfma_f32_16x16x32_bf16 v[184:187], v[76:79], a[88:91], v[184:187]
v_cvt_pk_bf16_f32 v109, v174, v178
v_mfma_f32_16x16x32_bf16 v[184:187], v[80:83], a[92:95], v[184:187]
v_cvt_pk_bf16_f32 v113, v175, v179
v_mfma_f32_16x16x32_bf16 v[188:191], v[68:71], a[96:99], 0
v_bfi_b32 v101, s83, v241, v101
v_mfma_f32_16x16x32_bf16 v[188:191], v[72:75], a[100:103], v[188:191]
v_bfi_b32 v105, s83, v241, v105
v_mfma_f32_16x16x32_bf16 v[188:191], v[76:79], a[104:107], v[188:191]
v_bfi_b32 v109, s83, v241, v109
v_mfma_f32_16x16x32_bf16 v[188:191], v[80:83], a[108:111], v[188:191]
v_bfi_b32 v113, s83, v241, v113
v_mfma_f32_16x16x32_bf16 v[192:195], v[68:71], a[112:115], 0
v_cvt_pk_bf16_f32 v102, v180, v184
v_mfma_f32_16x16x32_bf16 v[192:195], v[72:75], a[116:119], v[192:195]
v_cvt_pk_bf16_f32 v106, v181, v185
v_mfma_f32_16x16x32_bf16 v[192:195], v[76:79], a[120:123], v[192:195]
s_cmp_lg_u32 s3, 0
s_cbranch_scc1 L_nost_27
s_waitcnt lgkmcnt(0)
v_mov_b32 v152, v237
v_add_f32 v244, v244, v245
v_add_f32 v246, v246, v247
v_mov_b32 v154, s30
v_mov_b32 v155, s30
v_add_f32_e64 v153, v244, v246
buffer_store_dwordx4 v[152:155], v235, s[32:35], s80 offen sc1
L_nost_27:
v_mfma_f32_16x16x32_bf16 v[192:195], v[80:83], a[124:127], v[192:195]
v_cvt_pk_bf16_f32 v110, v182, v186
v_mfma_f32_16x16x32_bf16 v[196:199], v[84:87], a[0:3], 0
v_cvt_pk_bf16_f32 v114, v183, v187
v_mfma_f32_16x16x32_bf16 v[196:199], v[88:91], a[4:7], v[196:199]
v_mfma_f32_16x16x32_bf16 v[196:199], v[92:95], a[8:11], v[196:199]
v_mfma_f32_16x16x32_bf16 v[196:199], v[96:99], a[12:15], v[196:199]
v_mfma_f32_16x16x32_bf16 v[200:203], v[84:87], a[16:19], 0
v_mfma_f32_16x16x32_bf16 v[200:203], v[88:91], a[20:23], v[200:203]
v_cvt_pk_bf16_f32 v103, v188, v192
v_mfma_f32_16x16x32_bf16 v[200:203], v[92:95], a[24:27], v[200:203]
v_cvt_pk_bf16_f32 v107, v189, v193
v_mfma_f32_16x16x32_bf16 v[200:203], v[96:99], a[28:31], v[200:203]
v_cvt_pk_bf16_f32 v111, v190, v194
v_mfma_f32_16x16x32_bf16 v[204:207], v[84:87], a[32:35], 0
v_cvt_pk_bf16_f32 v115, v191, v195
v_mfma_f32_16x16x32_bf16 v[204:207], v[88:91], a[36:39], v[204:207]
buffer_store_dwordx4 v[100:103], v28, s[32:35], s60 offen sc1
v_mfma_f32_16x16x32_bf16 v[204:207], v[92:95], a[40:43], v[204:207]
buffer_store_dwordx4 v[104:107], v29, s[32:35], s61 offen sc1
v_mfma_f32_16x16x32_bf16 v[204:207], v[96:99], a[44:47], v[204:207]
buffer_store_dwordx4 v[108:111], v30, s[32:35], s62 offen sc1
buffer_store_dwordx4 v[112:115], v31, s[32:35], s63 offen sc1
v_mfma_f32_16x16x32_bf16 v[208:211], v[84:87], a[48:51], 0
v_cvt_pk_bf16_f32 v116, v196, v200
v_mfma_f32_16x16x32_bf16 v[208:211], v[88:91], a[52:55], v[208:211]
v_cvt_pk_bf16_f32 v120, v197, v201
v_mfma_f32_16x16x32_bf16 v[208:211], v[92:95], a[56:59], v[208:211]
v_cvt_pk_bf16_f32 v124, v198, v202
v_mfma_f32_16x16x32_bf16 v[208:211], v[96:99], a[60:63], v[208:211]
v_cvt_pk_bf16_f32 v128, v199, v203
v_mfma_f32_16x16x32_bf16 v[212:215], v[84:87], a[64:67], 0
v_bfi_b32 v116, s83, v240, v116
v_mfma_f32_16x16x32_bf16 v[212:215], v[88:91], a[68:71], v[212:215]
v_bfi_b32 v120, s83, v240, v120
v_mfma_f32_16x16x32_bf16 v[212:215], v[92:95], a[72:75], v[212:215]
v_bfi_b32 v124, s83, v240, v124
v_mfma_f32_16x16x32_bf16 v[212:215], v[96:99], a[76:79], v[212:215]
v_bfi_b32 v128, s83, v240, v128
v_mfma_f32_16x16x32_bf16 v[216:219], v[84:87], a[80:83], 0
v_cvt_pk_bf16_f32 v117, v204, v208
v_mfma_f32_16x16x32_bf16 v[216:219], v[88:91], a[84:87], v[216:219]
v_cvt_pk_bf16_f32 v121, v205, v209
v_mfma_f32_16x16x32_bf16 v[216:219], v[92:95], a[88:91], v[216:219]
v_cvt_pk_bf16_f32 v125, v206, v210
v_mfma_f32_16x16x32_bf16 v[216:219], v[96:99], a[92:95], v[216:219]
v_cvt_pk_bf16_f32 v129, v207, v211
v_mfma_f32_16x16x32_bf16 v[220:223], v[84:87], a[96:99], 0
v_bfi_b32 v117, s83, v241, v117
v_mfma_f32_16x16x32_bf16 v[220:223], v[88:91], a[100:103], v[220:223]
v_bfi_b32 v121, s83, v241, v121
v_mfma_f32_16x16x32_bf16 v[220:223], v[92:95], a[104:107], v[220:223]
v_bfi_b32 v125, s83, v241, v125
v_mfma_f32_16x16x32_bf16 v[220:223], v[96:99], a[108:111], v[220:223]
v_bfi_b32 v129, s83, v241, v129
v_mfma_f32_16x16x32_bf16 v[224:227], v[84:87], a[112:115], 0
v_cvt_pk_bf16_f32 v118, v212, v216
v_mfma_f32_16x16x32_bf16 v[224:227], v[88:91], a[116:119], v[224:227]
v_cvt_pk_bf16_f32 v122, v213, v217
v_mfma_f32_16x16x32_bf16 v[224:227], v[92:95], a[120:123], v[224:227]
v_cvt_pk_bf16_f32 v126, v214, v218
v_mfma_f32_16x16x32_bf16 v[224:227], v[96:99], a[124:127], v[224:227]
v_cvt_pk_bf16_f32 v130, v215, v219
s_nop 6
v_cvt_pk_bf16_f32 v119, v220, v224
buffer_store_dwordx4 v[116:119], v32, s[32:35], s64 offen sc1
v_cvt_pk_bf16_f32 v123, v221, v225
buffer_store_dwordx4 v[120:123], v33, s[32:35], s65 offen sc1
v_cvt_pk_bf16_f32 v127, v222, v226
buffer_store_dwordx4 v[124:127], v34, s[32:35], s66 offen sc1
v_cvt_pk_bf16_f32 v131, v223, v227
buffer_store_dwordx4 v[128:131], v35, s[32:35], s67 offen sc1
s_endpgm
L_help_4:
v_lshrrev_b32 v56, 4, v1
v_and_b32 v57, 15, v1
v_lshlrev_b32_e64 v57, 4, v57
v_lshl_add_u32 v56, v56, 13, v57
s_lshl_b32 s79, s31, 1
s_add_u32 s79, s79, s3
s_add_u32 s79, s79, 8
s_lshl_b32 s79, s79, 17
s_or_b32 s74, s72, 1
s_and_b32 s74, s74, 0x1d
s_lshl_b32 s74, s74, 8
s_add_u32 s79, s79, s74
s_add_u32 m0, s77, 98304
s_add_u32 s74, s79, 0
buffer_load_dwordx4 v56, s[44:47], s74 offen lds
s_add_u32 m0, s77, 99328
s_add_u32 s74, s79, 32768
buffer_load_dwordx4 v56, s[44:47], s74 offen lds
s_add_u32 m0, s77, 100352
s_add_u32 s74, s79, 65536
buffer_load_dwordx4 v56, s[44:47], s74 offen lds
s_add_u32 m0, s77, 101376
s_add_u32 s74, s79, 98304
buffer_load_dwordx4 v56, s[44:47], s74 offen lds
s_branch L_nocpf_3
L_ordb_5:
s_add_u32 m0, s77, 98304
s_add_u32 s74, s98, 0
buffer_load_dwordx4 v8, s[48:51], s74 offen  lds
s_add_u32 m0, s77, 99328
s_add_u32 s74, s98, 4096
buffer_load_dwordx4 v9, s[48:51], s74 offen  lds
s_add_u32 m0, s77, 100352
s_add_u32 s74, s98, 8192
buffer_load_dwordx4 v10, s[48:51], s74 offen  lds
s_add_u32 m0, s77, 101376
s_add_u32 s74, s98, 12288
buffer_load_dwordx4 v11, s[48:51], s74 offen  lds
s_add_u32 m0, s77, 102400
s_add_u32 s74, s98, 16384
buffer_load_dwordx4 v8, s[48:51], s74 offen  lds
s_add_u32 m0, s77, 103424
s_add_u32 s74, s98, 20480
buffer_load_dwordx4 v9, s[48:51], s74 offen  lds
s_add_u32 m0, s77, 104448
s_add_u32 s74, s98, 24576
buffer_load_dwordx4 v10, s[48:51], s74 offen  lds
s_add_u32 m0, s77, 105472
s_add_u32 s74, s98, 28672
buffer_load_dwordx4 v11, s[48:51], s74 offen  lds
s_add_u32 m0, s100, 16384
s_add_u32 s74, s99, 0
buffer_load_dwordx4 v8, s[56:59], s74 offen  lds
s_add_u32 m0, s100, 17408
s_add_u32 s74, s99, 4096
buffer_load_dwordx4 v9, s[56:59], s74 offen  lds
s_add_u32 m0, s100, 18432
s_add_u32 s74, s99, 8192
buffer_load_dwordx4 v10, s[56:59], s74 offen  lds
s_add_u32 m0, s100, 19456
s_add_u32 s74, s99, 12288
buffer_load_dwordx4 v11, s[56:59], s74 offen  lds
s_add_u32 m0, s77, 65536
s_add_u32 s74, s5, 0
buffer_load_dwordx4 v12, s[44:47], s74 offen  lds
s_add_u32 m0, s77, 66560
s_add_u32 s74, s5, 524288
buffer_load_dwordx4 v13, s[44:47], s74 offen  lds
s_add_u32 m0, s77, 67584
s_add_u32 s74, s5, 8192
buffer_load_dwordx4 v14, s[44:47], s74 offen  lds
s_add_u32 m0, s77, 68608
s_add_u32 s74, s5, 532480
buffer_load_dwordx4 v15, s[44:47], s74 offen  lds
s_add_u32 m0, s77, 69632
s_add_u32 s74, s5, 16384
buffer_load_dwordx4 v12, s[44:47], s74 offen  lds
s_add_u32 m0, s77, 70656
s_add_u32 s74, s5, 540672
buffer_load_dwordx4 v13, s[44:47], s74 offen  lds
s_add_u32 m0, s77, 71680
s_add_u32 s74, s5, 24576
buffer_load_dwordx4 v14, s[44:47], s74 offen  lds
s_add_u32 m0, s77, 72704
s_add_u32 s74, s5, 548864
buffer_load_dwordx4 v15, s[44:47], s74 offen  lds
s_branch L_orde_6
L_vt_8:
v_mov_b32_e64 v57, 0
global_load_dword v56, v57, s[26:27] offset:192 sc1
s_add_u32 s94, s94, 1
s_waitcnt vmcnt(0)
v_readfirstlane_b32 s6, v56
s_cmp_ge_u32 s94, 40000
s_cbranch_scc1 L_vt_ok_9
s_lshr_b32 s74, s6, 24
s_cmp_eq_u32 s74, 64
s_cbranch_scc0 L_vt_8
s_branch L_vt_ok_9
L_o_12:
buffer_load_dwordx4 v[128:131], v48, s[32:35], s78 offen sc1
buffer_load_dwordx4 v[132:135], v49, s[32:35], s78 offen sc1
buffer_load_dwordx4 v[136:139], v50, s[32:35], s78 offen sc1
buffer_load_dwordx4 v[140:143], v51, s[32:35], s78 offen sc1
buffer_load_dwordx4 v[144:147], v52, s[32:35], s78 offen sc1
buffer_load_dwordx4 v[148:151], v53, s[32:35], s78 offen sc1
buffer_load_dwordx4 v[152:155], v54, s[32:35], s78 offen sc1
buffer_load_dwordx4 v[156:159], v55, s[32:35], s78 offen sc1
s_waitcnt vmcnt(7)
v_xor_b32 v128, v128, v4
v_xor_b32_e64 v129, v129, v5
v_dot2_f32_bf16 v220, v128, v204, 0
v_dot2_f32_bf16 v221, v128, v212, 0
v_dot2_f32_bf16 v222, v129, v204, 0
v_dot2_f32_bf16 v223, v129, v212, 0
v_dot2_f32_bf16 v224, v130, v204, 0
v_dot2_f32_bf16 v225, v130, v212, 0
v_dot2_f32_bf16 v226, v131, v204, 0
v_dot2_f32_bf16 v227, v131, v212, 0
v_or_b32 v56, v128, v129
s_waitcnt vmcnt(6)
v_xor_b32 v132, v132, v4
v_xor_b32 v133, v133, v5
v_dot2_f32_bf16 v220, v132, v205, v220
v_dot2_f32_bf16 v221, v132, v213, v221
v_dot2_f32_bf16 v222, v133, v205, v222
v_dot2_f32_bf16 v223, v133, v213, v223
v_dot2_f32_bf16 v224, v134, v205, v224
v_dot2_f32_bf16 v225, v134, v213, v225
v_dot2_f32_bf16 v226, v135, v205, v226
v_dot2_f32_bf16 v227, v135, v213, v227
v_or3_b32 v56, v132, v133, v56
s_waitcnt vmcnt(5)
v_xor_b32 v136, v136, v4
v_xor_b32_e64 v137, v137, v5
v_dot2_f32_bf16 v220, v136, v206, v220
v_dot2_f32_bf16 v221, v136, v214, v221
v_dot2_f32_bf16 v222, v137, v206, v222
v_dot2_f32_bf16 v223, v137, v214, v223
v_dot2_f32_bf16 v224, v138, v206, v224
v_dot2_f32_bf16 v225, v138, v214, v225
v_dot2_f32_bf16 v226, v139, v206, v226
v_dot2_f32_bf16 v227, v139, v214, v227
v_or3_b32 v56, v136, v137, v56
s_waitcnt vmcnt(4)
v_xor_b32 v140, v140, v4
v_xor_b32_e64 v141, v141, v5
v_dot2_f32_bf16 v220, v140, v207, v220
v_dot2_f32_bf16 v221, v140, v215, v221
v_dot2_f32_bf16 v222, v141, v207, v222
v_dot2_f32_bf16 v223, v141, v215, v223
v_dot2_f32_bf16 v224, v142, v207, v224
v_dot2_f32_bf16 v225, v142, v215, v225
v_dot2_f32_bf16 v226, v143, v207, v226
v_dot2_f32_bf16 v227, v143, v215, v227
v_or3_b32 v56, v140, v141, v56
s_waitcnt vmcnt(3)
v_xor_b32 v144, v144, v4
v_xor_b32_e64 v145, v145, v5
v_dot2_f32_bf16 v220, v144, v208, v220
v_dot2_f32_bf16 v221, v144, v216, v221
v_dot2_f32_bf16 v222, v145, v208, v222
v_dot2_f32_bf16 v223, v145, v216, v223
v_dot2_f32_bf16 v224, v146, v208, v224
v_dot2_f32_bf16 v225, v146, v216, v225
v_dot2_f32_bf16 v226, v147, v208, v226
v_dot2_f32_bf16 v227, v147, v216, v227
v_or3_b32 v56, v144, v145, v56
s_waitcnt vmcnt(2)
v_xor_b32 v148, v148, v4
v_xor_b32_e64 v149, v149, v5
v_dot2_f32_bf16 v220, v148, v209, v220
v_dot2_f32_bf16 v221, v148, v217, v221
v_dot2_f32_bf16 v222, v149, v209, v222
v_dot2_f32_bf16 v223, v149, v217, v223
v_dot2_f32_bf16 v224, v150, v209, v224
v_dot2_f32_bf16 v225, v150, v217, v225
v_dot2_f32_bf16 v226, v151, v209, v226
v_dot2_f32_bf16 v227, v151, v217, v227
v_or3_b32 v56, v148, v149, v56
s_waitcnt vmcnt(1)
v_xor_b32 v152, v152, v4
v_xor_b32_e64 v153, v153, v5
v_dot2_f32_bf16 v220, v152, v210, v220
v_dot2_f32_bf16 v221, v152, v218, v221
v_dot2_f32_bf16 v222, v153, v210, v222
v_dot2_f32_bf16 v223, v153, v218, v223
v_dot2_f32_bf16 v224, v154, v210, v224
v_dot2_f32_bf16 v225, v154, v218, v225
v_dot2_f32_bf16 v226, v155, v210, v226
v_dot2_f32_bf16 v227, v155, v218, v227
v_or3_b32 v56, v152, v153, v56
s_waitcnt vmcnt(0)
v_xor_b32 v156, v156, v4
v_xor_b32_e64 v157, v157, v5
v_dot2_f32_bf16 v220, v156, v211, v220
v_dot2_f32_bf16 v221, v156, v219, v221
v_dot2_f32_bf16 v222, v157, v211, v222
v_dot2_f32_bf16 v223, v157, v219, v223
v_dot2_f32_bf16 v224, v158, v211, v224
v_dot2_f32_bf16 v225, v158, v219, v225
v_dot2_f32_bf16 v226, v159, v211, v226
v_dot2_f32_bf16 v227, v159, v219, v227
v_or3_b32 v56, v156, v157, v56
v_cvt_pk_bf16_f32 v192, v220, v221
v_cvt_pk_bf16_f32 v193, v222, v223
v_cvt_pk_bf16_f32 v194, v224, v225
v_cvt_pk_bf16_f32 v195, v226, v227
ds_write_b128 v228, v[192:195]
v_and_b32 v56, 0x00010001, v56
v_cmp_ne_u32 vcc, 0, v56
s_cbranch_vccz L_o_ok_13
s_add_u32 s94, s94, 1
s_cmp_lt_u32 s94, 40000
s_cbranch_scc1 L_o_12
s_branch L_o_ok_13
L_h1b_14:
buffer_load_dwordx2 v[20:21], v196, s[32:35], s85 offen sc1
buffer_load_dwordx2 v[22:23], v196, s[32:35], s86 offen sc1
buffer_load_dwordx2 v[24:25], v196, s[32:35], s87 offen sc1
s_waitcnt vmcnt(0)
v_xor_b32 v56, s30, v21
v_xor_b32 v57, s30, v23
v_xor_b32_e64 v58, s30, v25
v_or3_b32 v56, v56, v57, v58
v_cmp_ne_u32 vcc, 0, v56
s_cbranch_vccz L_h1b_ok_15
s_add_u32 s94, s94, 1
s_cmp_lt_u32 s94, 40000
s_cbranch_scc1 L_h1b_14
s_branch L_h1b_ok_15
L_bump:
s_lshl_b32 s74, s2, 2
s_add_u32 s74, s74, s3
s_cmp_lg_u32 s74, 3
s_cbranch_scc1 L_ft_end
s_mov_b64 exec, 1
v_mov_b32_e64 v59, 0
buffer_store_dword v191, v59, s[32:35], 0 offen sc1
s_branch L_ft_end
L_q_23:
s_add_u32 s94, s94, 1
s_cmp_ge_u32 s94, 40000
s_cbranch_scc1 L_q_done_28
s_mov_b64 exec, vcc
buffer_load_dwordx4 v[68:71], v16, s[32:35], s78 offen offset:0 sc1
buffer_load_dwordx4 v[72:75], v16, s[32:35], s78 offen offset:128 sc1
buffer_load_dwordx4 v[76:79], v16, s[32:35], s78 offen offset:256 sc1
buffer_load_dwordx4 v[80:83], v16, s[32:35], s78 offen offset:384 sc1
buffer_load_dwordx4 v[84:87], v16, s[32:35], s78 offen offset:512 sc1
buffer_load_dwordx4 v[88:91], v16, s[32:35], s78 offen offset:640 sc1
buffer_load_dwordx4 v[92:95], v16, s[32:35], s78 offen offset:768 sc1
buffer_load_dwordx4 v[96:99], v16, s[32:35], s78 offen offset:896 sc1
buffer_load_dwordx4 v[100:103], v16, s[32:35], s78 offen offset:1024 sc1
buffer_load_dwordx4 v[104:107], v16, s[32:35], s78 offen offset:1152 sc1
buffer_load_dwordx4 v[108:111], v16, s[32:35], s78 offen offset:1280 sc1
buffer_load_dwordx4 v[112:115], v16, s[32:35], s78 offen offset:1408 sc1
s_waitcnt vmcnt(0) lgkmcnt(0)
v_min3_u32 v8, v71, v75, v79
v_max3_u32 v9, v71, v75, v79
v_mov_b32 v71, v76
v_mov_b32_e64 v75, v77
ds_write_b128 v17, v[68:71] offset:0
ds_write_b128 v17, v[72:75] offset:512
v_min3_u32 v8, v8, v83, v87
v_max3_u32 v9, v9, v83, v87
v_mov_b32 v83, v88
v_mov_b32 v87, v89
ds_write_b128 v17, v[80:83] offset:8192
ds_write_b128 v17, v[84:87] offset:8704
v_min_u32 v8, v8, v91
v_max_u32 v9, v9, v91
v_min3_u32 v8, v8, v95, v99
v_max3_u32 v9, v9, v95, v99
v_mov_b32 v95, v100
v_mov_b32 v99, v101
ds_write_b128 v17, v[92:95] offset:16384
ds_write_b128 v17, v[96:99] offset:16896
v_min_u32 v8, v8, v103
v_max_u32 v9, v9, v103
v_min3_u32 v8, v8, v107, v111
v_max3_u32 v9, v9, v107, v111
v_mov_b32 v107, v112
v_mov_b32 v111, v113
ds_write_b128 v17, v[104:107] offset:24576
ds_write_b128 v17, v[108:111] offset:25088
v_min_u32 v8, v8, v115
v_max_u32 v9, v9, v115
v_xor_b32 v8, s30, v8
v_xor_b32 v9, s30, v9
v_or_b32 v8, v8, v9
v_cmp_ne_u32 vcc, 0, v8
s_cbranch_vccnz L_q_23
L_q_done_28:
s_mov_b64 exec, -1
s_branch L_q_ok_24
L_avt_25:
v_mov_b32 v9, 0
global_load_dword v8, v9, s[26:27] offset:192 sc1
s_add_u32 s94, s94, 1
s_waitcnt vmcnt(0)
v_readfirstlane_b32 s50, v8
s_cmp_ge_u32 s94, 40000
s_cbranch_scc1 L_avt_ok_26
s_lshr_b32 s74, s50, 24
s_cmp_eq_u32 s74, 64
s_cbranch_scc0 L_avt_25
s_branch L_avt_ok_26
L_exit:
s_endpgm
.section .rodata,"a"
.p2align 6
.amdhsa_kernel gated_mix__compressed_kv_cla__dense_activation_silu__decode_kernel
.amdhsa_next_free_vgpr 512
.amdhsa_next_free_sgpr 102
.amdhsa_accum_offset 256
.amdhsa_group_segment_fixed_size 0
.amdhsa_kernarg_size 104
.amdhsa_user_sgpr_count 2
.amdhsa_user_sgpr_kernarg_segment_ptr 1
.amdhsa_system_sgpr_workgroup_id_x 1
.end_amdhsa_kernel
```
